```python
import torch

def _softmax(x, axis=-1):
    return torch.softmax(x, dim=axis)
def _gelu(x):
    return torch.nn.functional.gelu(x, approximate="tanh")
def _silu(x):
    return torch.nn.functional.silu(x)
def _sigmoid(x):
    return torch.sigmoid(x)
def _layernorm(x, axis=-1, eps=1e-5):
    m = x.mean(dim=axis, keepdim=True)
    v = x.var(dim=axis, keepdim=True, unbiased=False)
    return (x - m) / torch.sqrt(v + eps)
def _scatter_add(tgt, idx, src, axis=0):
    return tgt.clone().index_add_(axis, idx, src)
def _segment_sum(src, seg, n):
    out = torch.zeros((n,) + src.shape[1:], dtype=src.dtype)
    return out.index_add_(0, seg, src)
def _pad(x, pw):
    flat = tuple(v for pair in reversed(pw) for v in pair)
    return torch.nn.functional.pad(x, flat)

kernel_name = 'sequential_preLN__grouped_kv_mqa__dense_activation_squared_relu__prompt'

def setup_inputs():

    _w = (lambda a: (lambda t: t.to(torch.bfloat16) if t.is_floating_point() else t)(torch.as_tensor(a)))
    def _A_setup():
        B, S, D, H = 1, 2048, 512, 32
        Dh = D // H
        return {
            "x": _w((lambda *s: torch.randn(*s, dtype=torch.bfloat16) * 0.05)(B, S, D)),
            "wq": _w((lambda *s: torch.randn(*s, dtype=torch.bfloat16) * 0.05)(D, H * Dh)),
            "wk": _w((lambda *s: torch.randn(*s, dtype=torch.bfloat16) * 0.05)(D, Dh)),
            "wv": _w((lambda *s: torch.randn(*s, dtype=torch.bfloat16) * 0.05)(D, Dh)),
            "wo": _w((lambda *s: torch.randn(*s, dtype=torch.bfloat16) * 0.05)(H * Dh, D)),
        }
    _A_in = _A_setup()

    def _B_setup():
        B, S, D, F = 1, 2048, 512, 1792
        return {
            "x": _w((lambda *s: torch.randn(*s, dtype=torch.bfloat16) * 0.05)(B, S, D)),
            "w1": _w((lambda *s: torch.randn(*s, dtype=torch.bfloat16) * 0.05)(D, F)),
            "b1": _w((lambda *s: torch.randn(*s, dtype=torch.bfloat16) * 0.4)(F)),
            "w2": _w((lambda *s: torch.randn(*s, dtype=torch.bfloat16) * 0.05)(F, D)),
            "b2": _w((lambda *s: torch.randn(*s, dtype=torch.bfloat16) * 1.6)(D)),
        }
    _B_in = _B_setup()

    return {
        "A_x": _A_in["x"],
        "A_wq": _A_in["wq"],
        "A_wk": _A_in["wk"],
        "A_wv": _A_in["wv"],
        "A_wo": _A_in["wo"],
        "B_x": _B_in["x"],
        "B_w1": _B_in["w1"],
        "B_b1": _B_in["b1"],
        "B_w2": _B_in["w2"],
        "B_b2": _B_in["b2"],
    }

def reference(A_x, A_wq, A_wk, A_wv, A_wo, B_x, B_w1, B_b1, B_w2, B_b2):
    def _A_ref(x, wq, wk, wv, wo):
        B, S, D = x.shape
        H = 32
        Dh = D // H
        q = (lambda x, *d: x.permute(*d))((x @ wq).reshape(B, S, H, Dh), 0, 2, 1, 3)
        k = x @ wk
        v = x @ wv
        scores = torch.einsum("bhqd,bkd->bhqk", q, k) * (Dh ** -0.5)
        p = _softmax(scores, axis=-1)
        o = torch.einsum("bhqk,bkd->bhqd", p, v)
        return (lambda x, *d: x.permute(*d))(o, 0, 2, 1, 3).reshape(B, S, H * Dh) @ wo

    def _B_ref(x, w1, b1, w2, b2):
        h = torch.einsum("bsd,df->bsf", x, w1) + b1
        zero = torch.zeros_like(h)
        r = torch.where(h > zero, h, zero)
        h = r * r
        out = torch.einsum("bsf,fd->bsd", h, w2) + b2
        return out

    x = A_x
    h = x + _A_ref(_layernorm(x, axis=-1), A_wq, A_wk, A_wv, A_wo)
    h2 = h + _B_ref(_layernorm(h, axis=-1), B_w1, B_b1, B_w2, B_b2)
    return h2
```

```asm
; @launch grid=(256,1,1) block=(512,1,1) lds=163840
.amdgcn_target "amdgcn-amd-amdhsa--gfx950"
.text
.globl sequential_preLN__grouped_kv_mqa__dense_activation_squared_relu__prompt_kernel
.p2align 8
.type sequential_preLN__grouped_kv_mqa__dense_activation_squared_relu__prompt_kernel,@function
sequential_preLN__grouped_kv_mqa__dense_activation_squared_relu__prompt_kernel:
    s_cmp_ge_u32 s2, 256
    s_cbranch_scc1 L_end
    s_load_dwordx16 s[64:79], s[0:1], 0
    s_load_dwordx8 s[80:87], s[0:1], 64
    s_load_dwordx2 s[88:89], s[0:1], 96
    s_and_b32 s92, s2, 7
    s_lshr_b32 s93, s2, 6
    s_lshl_b32 s93, s93, 3
    s_add_u32 s58, s92, s93
    s_lshr_b32 s57, s2, 3
    s_and_b32 s57, s57, 7
    s_lshl_b32 s59, s58, 6
    s_getreg_b32 s91, hwreg(HW_REG_XCC_ID)
    s_and_b32 s91, s91, 7
    v_lshrrev_b32 v3, 6, v0
    v_and_b32 v1, 63, v0
    v_readfirstlane_b32 s56, v3
    v_lshlrev_b32 v2, 4, v1
    s_lshr_b32 s90, s56, 2
    s_lshr_b32 s62, s56, 1
    s_and_b32 s62, s62, 1
    s_and_b32 s63, s56, 1
    s_waitcnt lgkmcnt(0)
    s_mov_b32 s8, s64
    s_mov_b32 s9, s65
    s_mov_b32 s10, 0x200000
    s_mov_b32 s11, 0x20000
    s_mov_b32 s48, s88
    s_mov_b32 s49, s89
    s_mov_b32 s50, 0x2000000
    s_mov_b32 s51, 0x20000
    s_load_dword s60, s[88:89], 0
    s_mov_b32 s16, s68
    s_mov_b32 s17, s69
    s_mov_b32 s18, 0x4000
    s_mov_b32 s19, 0x20000
    s_mov_b32 s20, s70
    s_mov_b32 s21, s71
    s_mov_b32 s22, 0x4000
    s_mov_b32 s23, 0x20000
    s_mov_b32 s12, s66
    s_mov_b32 s13, s67
    s_mov_b32 s14, 0x80000
    s_mov_b32 s15, 0x20000
    s_lshl_b32 s92, s57, 3
    s_add_u32 s92, s92, s59
    s_add_u32 s93, s92, s56
    s_lshl_b32 s93, s93, 10
    buffer_load_dwordx4 v[4:7], v2, s[8:11], s93 offen
    v_lshrrev_b32 v8, 3, v1
    v_and_b32 v9, 7, v1
    v_lshrrev_b32 v10, 1, v8
    v_xor_b32 v10, v10, v9
    s_and_b32 s93, s57, 1
    s_lshl_b32 s93, s93, 2
    v_xor_b32 v10, s93, v10
    v_lshlrev_b32 v10, 4, v10
    v_lshl_add_u32 v16, v8, 10, v10
    s_lshl_b32 s68, s59, 10
    s_lshl_b32 s94, s57, 13
    s_lshl_b32 s95, s56, 7
    s_add_u32 s94, s94, s95
    s_add_u32 s94, s94, s68
    s_lshl_b32 s95, s56, 13
    s_lshl_b32 s96, s57, 10
    s_add_u32 m0, s95, s96
    s_nop 0
    buffer_load_dwordx4 v16, s[8:11], s94 offen lds
    v_lshrrev_b32 v8, 1, v1
    v_and_b32 v9, 0x13, v8
    v_bfe_u32 v10, v8, 2, 1
    v_lshl_or_b32 v9, v10, 3, v9
    v_bfe_u32 v10, v8, 3, 1
    v_lshl_or_b32 v9, v10, 2, v9
    v_lshlrev_b32 v9, 5, v9
    v_and_b32 v10, 1, v1
    v_lshl_or_b32 v18, v10, 4, v9
    s_lshl_b32 s94, s56, 11
    s_add_u32 m0, s94, 65536
    s_nop 0
    buffer_load_dwordx4 v18, s[16:19], s94 offen lds
    s_add_u32 m0, s94, 81920
    s_nop 0
    buffer_load_dwordx4 v18, s[20:23], s94 offen lds
    s_add_u32 s94, s94, 1024
    s_add_u32 m0, s94, 65536
    s_nop 0
    buffer_load_dwordx4 v18, s[16:19], s94 offen lds
    s_add_u32 m0, s94, 81920
    s_nop 0
    buffer_load_dwordx4 v18, s[20:23], s94 offen lds
    v_lshrrev_b32 v8, 3, v1
    v_and_b32 v9, 7, v1
    v_bfe_u32 v10, v1, 4, 1
    v_lshlrev_b32 v10, 2, v10
    v_xor_b32 v9, v9, v10
    v_lshlrev_b32 v9, 4, v9
    v_lshl_add_u32 v19, v8, 10, v9
    s_add_u32 s67, s57, 1
    s_and_b32 s67, s67, 7
    s_mov_b32 s24, s72
    s_mov_b32 s25, s73
    s_mov_b32 s26, 0x80000
    s_mov_b32 s27, 0x20000
    s_mov_b32 s28, s76
    s_mov_b32 s29, s77
    s_mov_b32 s30, 0x1c0000
    s_mov_b32 s31, 0x20000
    s_mov_b32 s36, s78
    s_mov_b32 s37, s79
    s_mov_b32 s38, 0xe00
    s_mov_b32 s39, 0x20000
    s_mov_b32 s32, s80
    s_mov_b32 s33, s81
    s_mov_b32 s34, 0x1c0000
    s_mov_b32 s35, 0x20000
    s_mov_b32 s40, s82
    s_mov_b32 s41, s83
    s_mov_b32 s42, 0x400
    s_mov_b32 s43, 0x20000
    s_mov_b32 s44, s84
    s_mov_b32 s45, s85
    s_mov_b32 s46, 0x200000
    s_mov_b32 s47, 0x20000
    s_cmp_ge_u32 s56, 2
    s_cbranch_scc1 L_no_ones
    v_mov_b32 v64, 0x3f803f80
    v_mov_b32 v65, v64
    v_mov_b32 v66, v64
    v_mov_b32 v67, v64
    v_mov_b32 v68, v64
    v_mov_b32 v69, v64
    v_mov_b32 v70, v64
    v_mov_b32 v71, v64
    v_mov_b32 v72, v64
    v_mov_b32 v73, v64
    v_mov_b32 v74, v64
    v_mov_b32 v75, v64
    v_mov_b32 v76, v64
    v_mov_b32 v77, v64
    v_mov_b32 v78, v64
    v_mov_b32 v79, v64
    v_mov_b32 v80, v64
    v_mov_b32 v81, v64
    v_mov_b32 v82, v64
    v_mov_b32 v83, v64
    v_mov_b32 v84, v64
    v_mov_b32 v85, v64
    v_mov_b32 v86, v64
    v_mov_b32 v87, v64
    v_mov_b32 v88, v64
    v_mov_b32 v89, v64
    v_mov_b32 v90, v64
    v_mov_b32 v91, v64
    v_mov_b32 v92, v64
    v_mov_b32 v93, v64
    v_mov_b32 v94, v64
    v_mov_b32 v95, v64
    v_mov_b32 v96, v64
    v_mov_b32 v97, v64
    v_mov_b32 v98, v64
    v_mov_b32 v99, v64
    v_mov_b32 v100, v64
    v_mov_b32 v101, v64
    v_mov_b32 v102, v64
    v_mov_b32 v103, v64
    v_mov_b32 v104, v64
    v_mov_b32 v105, v64
    v_mov_b32 v106, v64
    v_mov_b32 v107, v64
    v_mov_b32 v108, v64
    v_mov_b32 v109, v64
    v_mov_b32 v110, v64
    v_mov_b32 v111, v64
    v_mov_b32 v112, v64
    v_mov_b32 v113, v64
    v_mov_b32 v114, v64
    v_mov_b32 v115, v64
    v_mov_b32 v116, v64
    v_mov_b32 v117, v64
    v_mov_b32 v118, v64
    v_mov_b32 v119, v64
    v_mov_b32 v120, v64
    v_mov_b32 v121, v64
    v_mov_b32 v122, v64
    v_mov_b32 v123, v64
    v_mov_b32 v124, v64
    v_mov_b32 v125, v64
    v_mov_b32 v126, v64
    v_mov_b32 v127, v64
L_no_ones:
    s_waitcnt vmcnt(5)
    s_lshr_b32 s92, s2, 6
    s_lshl_b32 s92, s92, 3
    s_add_u32 s92, s92, s56
    s_lshl_b32 s92, s92, 14
    s_lshl_b32 s93, s57, 7
    s_add_u32 s92, s92, s93
    v_lshlrev_b32 v62, 10, v1
    s_mov_b64 exec, 0xffff
    buffer_load_dword v63, v62, s[12:15], s92 offen
    s_mov_b64 exec, -1
    s_mov_b32 s3, 0x3f803f80
    v_dot2_f32_bf16 v8, v4, s3, 0
    v_dot2_f32_bf16 v9, v4, v4, 0
    v_dot2_f32_bf16 v8, v5, s3, v8
    v_dot2_f32_bf16 v9, v5, v5, v9
    v_dot2_f32_bf16 v8, v6, s3, v8
    v_dot2_f32_bf16 v9, v6, v6, v9
    v_dot2_f32_bf16 v8, v7, s3, v8
    v_dot2_f32_bf16 v9, v7, v7, v9
    s_nop 1
    v_add_f32_dpp v8, v8, v8 row_ror:8 row_mask:0xf bank_mask:0xf
    v_add_f32_dpp v9, v9, v9 row_ror:8 row_mask:0xf bank_mask:0xf
    s_nop 0
    v_add_f32_dpp v8, v8, v8 row_ror:4 row_mask:0xf bank_mask:0xf
    v_add_f32_dpp v9, v9, v9 row_ror:4 row_mask:0xf bank_mask:0xf
    s_nop 0
    v_add_f32_dpp v8, v8, v8 row_ror:2 row_mask:0xf bank_mask:0xf
    v_add_f32_dpp v9, v9, v9 row_ror:2 row_mask:0xf bank_mask:0xf
    s_nop 0
    v_add_f32_dpp v8, v8, v8 row_ror:1 row_mask:0xf bank_mask:0xf
    v_add_f32_dpp v9, v9, v9 row_ror:1 row_mask:0xf bank_mask:0xf
    v_mov_b32 v10, v8
    v_mov_b32 v11, v9
    s_nop 0
    v_permlane16_swap_b32 v8, v10
    v_permlane16_swap_b32 v9, v11
    v_add_f32 v8, v8, v10
    v_add_f32 v9, v9, v11
    v_mov_b32 v10, v8
    v_mov_b32 v11, v9
    s_nop 0
    v_permlane32_swap_b32 v8, v10
    v_permlane32_swap_b32 v9, v11
    v_add_f32 v8, v8, v10
    v_add_f32 v9, v9, v11
    v_mul_f32 v8, 0x3b000000, v8
    v_mul_f32 v9, 0x3b000000, v9
    v_fma_f32 v9, -v8, v8, v9
    v_max_f32 v9, 0, v9
    v_add_f32 v9, 0x3727c5ac, v9
    v_rsq_f32 v9, v9
    s_lshl_b32 s92, s56, 3
    s_lshl_b32 s93, s67, 10
    s_add_u32 s92, s92, s93
    v_lshlrev_b32 v10, 13, v1
    v_add_u32 v10, s92, v10
    s_mov_b64 exec, 3
    ds_write_b64 v10, v[8:9]
    s_mov_b64 exec, -1
    s_waitcnt vmcnt(1) lgkmcnt(0)
    s_barrier
    s_cmp_lt_u32 s56, 2
    s_cbranch_scc1 L_kv_go
    s_sub_u32 s92, s56, 2
    s_add_u32 s93, s92, 2
    s_lshr_b32 s4, s93, 3
    s_add_u32 s4, s4, 1
    s_and_b32 s5, s4, 1
    s_lshl_b32 s5, s5, 6
    v_xor_b32 v17, s5, v16
    s_add_u32 s4, s4, s57
    s_and_b32 s4, s4, 7
    s_and_b32 s5, s93, 7
    s_lshl_b32 s94, s4, 13
    s_lshl_b32 s95, s5, 7
    s_add_u32 s94, s94, s95
    s_add_u32 s94, s94, s68
    s_lshl_b32 s95, s5, 13
    s_lshl_b32 s96, s4, 10
    s_add_u32 m0, s95, s96
    s_nop 0
    buffer_load_dwordx4 v17, s[8:11], s94 offen lds
    s_add_u32 s93, s93, 6
    s_lshr_b32 s4, s93, 3
    s_add_u32 s4, s4, 1
    s_and_b32 s5, s4, 1
    s_lshl_b32 s5, s5, 6
    v_xor_b32 v17, s5, v16
    s_add_u32 s4, s4, s57
    s_and_b32 s4, s4, 7
    s_and_b32 s5, s93, 7
    s_lshl_b32 s94, s4, 13
    s_lshl_b32 s95, s5, 7
    s_add_u32 s94, s94, s95
    s_add_u32 s94, s94, s68
    s_lshl_b32 s95, s5, 13
    s_lshl_b32 s96, s4, 10
    s_add_u32 m0, s95, s96
    s_nop 0
    buffer_load_dwordx4 v17, s[8:11], s94 offen lds
    s_add_u32 s93, s93, 6
    s_lshr_b32 s4, s93, 3
    s_add_u32 s4, s4, 1
    s_and_b32 s5, s4, 1
    s_lshl_b32 s5, s5, 6
    v_xor_b32 v17, s5, v16
    s_add_u32 s4, s4, s57
    s_and_b32 s4, s4, 7
    s_and_b32 s5, s93, 7
    s_lshl_b32 s94, s4, 13
    s_lshl_b32 s95, s5, 7
    s_add_u32 s94, s94, s95
    s_add_u32 s94, s94, s68
    s_lshl_b32 s95, s5, 13
    s_lshl_b32 s96, s4, 10
    s_add_u32 m0, s95, s96
    s_nop 0
    buffer_load_dwordx4 v17, s[8:11], s94 offen lds
    s_add_u32 s93, s93, 6
    s_lshr_b32 s4, s93, 3
    s_add_u32 s4, s4, 1
    s_and_b32 s5, s4, 1
    s_lshl_b32 s5, s5, 6
    v_xor_b32 v17, s5, v16
    s_add_u32 s4, s4, s57
    s_and_b32 s4, s4, 7
    s_and_b32 s5, s93, 7
    s_lshl_b32 s94, s4, 13
    s_lshl_b32 s95, s5, 7
    s_add_u32 s94, s94, s95
    s_add_u32 s94, s94, s68
    s_lshl_b32 s95, s5, 13
    s_lshl_b32 s96, s4, 10
    s_add_u32 m0, s95, s96
    s_nop 0
    buffer_load_dwordx4 v17, s[8:11], s94 offen lds
    s_add_u32 s93, s93, 6
    s_lshr_b32 s4, s93, 3
    s_add_u32 s4, s4, 1
    s_and_b32 s5, s4, 1
    s_lshl_b32 s5, s5, 6
    v_xor_b32 v17, s5, v16
    s_add_u32 s4, s4, s57
    s_and_b32 s4, s4, 7
    s_and_b32 s5, s93, 7
    s_lshl_b32 s94, s4, 13
    s_lshl_b32 s95, s5, 7
    s_add_u32 s94, s94, s95
    s_add_u32 s94, s94, s68
    s_lshl_b32 s95, s5, 13
    s_lshl_b32 s96, s4, 10
    s_add_u32 m0, s95, s96
    s_nop 0
    buffer_load_dwordx4 v17, s[8:11], s94 offen lds
    s_add_u32 s93, s93, 6
    s_lshr_b32 s4, s93, 3
    s_add_u32 s4, s4, 1
    s_and_b32 s5, s4, 1
    s_lshl_b32 s5, s5, 6
    v_xor_b32 v17, s5, v16
    s_add_u32 s4, s4, s57
    s_and_b32 s4, s4, 7
    s_and_b32 s5, s93, 7
    s_lshl_b32 s94, s4, 13
    s_lshl_b32 s95, s5, 7
    s_add_u32 s94, s94, s95
    s_add_u32 s94, s94, s68
    s_lshl_b32 s95, s5, 13
    s_lshl_b32 s96, s4, 10
    s_add_u32 m0, s95, s96
    s_nop 0
    buffer_load_dwordx4 v17, s[8:11], s94 offen lds
    s_add_u32 s93, s93, 6
    s_lshr_b32 s4, s93, 3
    s_add_u32 s4, s4, 1
    s_and_b32 s5, s4, 1
    s_lshl_b32 s5, s5, 6
    v_xor_b32 v17, s5, v16
    s_add_u32 s4, s4, s57
    s_and_b32 s4, s4, 7
    s_and_b32 s5, s93, 7
    s_lshl_b32 s94, s4, 13
    s_lshl_b32 s95, s5, 7
    s_add_u32 s94, s94, s95
    s_add_u32 s94, s94, s68
    s_lshl_b32 s95, s5, 13
    s_lshl_b32 s96, s4, 10
    s_add_u32 m0, s95, s96
    s_nop 0
    buffer_load_dwordx4 v17, s[8:11], s94 offen lds
    s_add_u32 s93, s93, 6
    s_lshr_b32 s4, s93, 3
    s_add_u32 s4, s4, 1
    s_and_b32 s5, s4, 1
    s_lshl_b32 s5, s5, 6
    v_xor_b32 v17, s5, v16
    s_add_u32 s4, s4, s57
    s_and_b32 s4, s4, 7
    s_and_b32 s5, s93, 7
    s_lshl_b32 s94, s4, 13
    s_lshl_b32 s95, s5, 7
    s_add_u32 s94, s94, s95
    s_add_u32 s94, s94, s68
    s_lshl_b32 s95, s5, 13
    s_lshl_b32 s96, s4, 10
    s_add_u32 m0, s95, s96
    s_nop 0
    buffer_load_dwordx4 v17, s[8:11], s94 offen lds
    s_add_u32 s93, s93, 6
    s_lshr_b32 s4, s93, 3
    s_add_u32 s4, s4, 1
    s_and_b32 s5, s4, 1
    s_lshl_b32 s5, s5, 6
    v_xor_b32 v17, s5, v16
    s_add_u32 s4, s4, s57
    s_and_b32 s4, s4, 7
    s_and_b32 s5, s93, 7
    s_lshl_b32 s94, s4, 13
    s_lshl_b32 s95, s5, 7
    s_add_u32 s94, s94, s95
    s_add_u32 s94, s94, s68
    s_lshl_b32 s95, s5, 13
    s_lshl_b32 s96, s4, 10
    s_add_u32 m0, s95, s96
    s_nop 0
    buffer_load_dwordx4 v17, s[8:11], s94 offen lds
    s_lshl_b32 s94, s92, 13
    s_lshl_b32 s95, s57, 7
    s_add_u32 s94, s94, s95
    s_lshl_b32 s95, s92, 10
    s_add_u32 s95, s95, 98304
    s_mov_b32 m0, s95
    s_nop 0
    buffer_load_dwordx4 v19, s[12:15], s94 offen lds
    s_add_u32 s94, s94, 49152
    s_add_u32 s95, s95, 6144
    s_mov_b32 m0, s95
    s_nop 0
    buffer_load_dwordx4 v19, s[12:15], s94 offen lds
    s_add_u32 s94, s94, 49152
    s_add_u32 s95, s95, 6144
    s_mov_b32 m0, s95
    s_nop 0
    buffer_load_dwordx4 v19, s[12:15], s94 offen lds
    s_add_u32 s94, s94, 49152
    s_add_u32 s95, s95, 6144
    s_mov_b32 m0, s95
    s_nop 0
    buffer_load_dwordx4 v19, s[12:15], s94 offen lds
    s_add_u32 s94, s94, 49152
    s_add_u32 s95, s95, 6144
    s_mov_b32 m0, s95
    s_nop 0
    buffer_load_dwordx4 v19, s[12:15], s94 offen lds
    s_add_u32 s94, s94, 49152
    s_add_u32 s95, s95, 6144
    s_mov_b32 m0, s95
    s_nop 0
    buffer_load_dwordx4 v19, s[12:15], s94 offen lds
    s_add_u32 s94, s94, 49152
    s_add_u32 s95, s95, 6144
    s_mov_b32 m0, s95
    s_nop 0
    buffer_load_dwordx4 v19, s[12:15], s94 offen lds
    s_add_u32 s94, s94, 49152
    s_add_u32 s95, s95, 6144
    s_mov_b32 m0, s95
    s_nop 0
    buffer_load_dwordx4 v19, s[12:15], s94 offen lds
    s_add_u32 s94, s94, 49152
    s_add_u32 s95, s95, 6144
    s_mov_b32 m0, s95
    s_nop 0
    buffer_load_dwordx4 v19, s[12:15], s94 offen lds
    s_add_u32 s94, s94, 49152
    s_add_u32 s95, s95, 6144
    s_mov_b32 m0, s95
    s_nop 0
    buffer_load_dwordx4 v19, s[12:15], s94 offen lds
    s_add_u32 s94, s94, 49152
    s_add_u32 s95, s95, 6144
    s_cmp_ge_u32 s92, 4
    s_cbranch_scc1 L_blk_done
    s_mov_b32 m0, s95
    s_nop 0
    buffer_load_dwordx4 v19, s[12:15], s94 offen lds
L_blk_done:
    s_branch L_kv_done
L_kv_go:
    v_and_b32 v8, 7, v1
    s_lshl_b32 s92, s57, 3
    v_add_u32 v8, s92, v8
    v_bfe_u32 v9, v8, 1, 3
    v_lshrrev_b32 v10, 4, v1
    v_xor_b32 v9, v9, v10
    v_lshlrev_b32 v9, 4, v9
    v_lshl_add_u32 v20, v8, 7, v9
    v_xor_b32 v21, 64, v20
    v_bfe_u32 v8, v1, 4, 1
    v_bfe_u32 v9, v1, 2, 2
    v_lshl_add_u32 v8, v8, 2, v9
    v_lshlrev_b32 v8, 5, v8
    v_lshrrev_b32 v9, 5, v1
    v_lshl_add_u32 v8, v9, 9, v8
    v_and_b32 v9, 3, v1
    v_lshl_add_u32 v8, v9, 3, v8
    s_lshl_b32 s92, s56, 14
    s_add_u32 s92, s92, 65536
    v_add_u32 v22, s92, v8
    s_mov_b32 exec_lo, 0x00ff00ff
    s_mov_b32 exec_hi, 0x00ff00ff
    ds_read_b128 v[64:67], v20 offset:0
    ds_read_b128 v[68:71], v21 offset:0
    ds_read_b128 v[72:75], v20 offset:8192
    ds_read_b128 v[76:79], v21 offset:8192
    ds_read_b128 v[80:83], v20 offset:16384
    ds_read_b128 v[84:87], v21 offset:16384
    ds_read_b128 v[88:91], v20 offset:24576
    ds_read_b128 v[92:95], v21 offset:24576
    ds_read_b128 v[96:99], v20 offset:32768
    ds_read_b128 v[100:103], v21 offset:32768
    ds_read_b128 v[104:107], v20 offset:40960
    ds_read_b128 v[108:111], v21 offset:40960
    ds_read_b128 v[112:115], v20 offset:49152
    ds_read_b128 v[116:119], v21 offset:49152
    ds_read_b128 v[120:123], v20 offset:57344
    ds_read_b128 v[124:127], v21 offset:57344
    s_mov_b64 exec, -1
    s_cmp_eq_u32 s56, 1
    s_cbranch_scc1 L_vwave
    ds_read_b64_tr_b16 v[128:129], v22 offset:0
    ds_read_b64_tr_b16 v[130:131], v22 offset:256
    ds_read_b64_tr_b16 v[132:133], v22 offset:1024
    ds_read_b64_tr_b16 v[134:135], v22 offset:1280
    ds_read_b64_tr_b16 v[136:137], v22 offset:2048
    ds_read_b64_tr_b16 v[138:139], v22 offset:2304
    ds_read_b64_tr_b16 v[140:141], v22 offset:3072
    ds_read_b64_tr_b16 v[142:143], v22 offset:3328
    s_waitcnt lgkmcnt(6)
    v_mfma_f32_16x16x32_bf16 v[24:27], v[128:131], v[64:67], 0
    ds_read_b64_tr_b16 v[144:145], v22 offset:4096
    ds_read_b64_tr_b16 v[146:147], v22 offset:4352
    s_waitcnt lgkmcnt(6)
    v_mfma_f32_16x16x32_bf16 v[24:27], v[132:135], v[68:71], v[24:27]
    ds_read_b64_tr_b16 v[148:149], v22 offset:5120
    ds_read_b64_tr_b16 v[150:151], v22 offset:5376
    s_waitcnt lgkmcnt(6)
    v_mfma_f32_16x16x32_bf16 v[24:27], v[136:139], v[72:75], v[24:27]
    ds_read_b64_tr_b16 v[152:153], v22 offset:6144
    ds_read_b64_tr_b16 v[154:155], v22 offset:6400
    s_waitcnt lgkmcnt(6)
    v_mfma_f32_16x16x32_bf16 v[24:27], v[140:143], v[76:79], v[24:27]
    ds_read_b64_tr_b16 v[156:157], v22 offset:7168
    ds_read_b64_tr_b16 v[158:159], v22 offset:7424
    s_waitcnt lgkmcnt(6)
    v_mfma_f32_16x16x32_bf16 v[24:27], v[144:147], v[80:83], v[24:27]
    ds_read_b64_tr_b16 v[160:161], v22 offset:8192
    ds_read_b64_tr_b16 v[162:163], v22 offset:8448
    s_waitcnt lgkmcnt(6)
    v_mfma_f32_16x16x32_bf16 v[24:27], v[148:151], v[84:87], v[24:27]
    ds_read_b64_tr_b16 v[164:165], v22 offset:9216
    ds_read_b64_tr_b16 v[166:167], v22 offset:9472
    s_waitcnt lgkmcnt(6)
    v_mfma_f32_16x16x32_bf16 v[24:27], v[152:155], v[88:91], v[24:27]
    ds_read_b64_tr_b16 v[168:169], v22 offset:10240
    ds_read_b64_tr_b16 v[170:171], v22 offset:10496
    s_waitcnt lgkmcnt(6)
    v_mfma_f32_16x16x32_bf16 v[24:27], v[156:159], v[92:95], v[24:27]
    ds_read_b64_tr_b16 v[172:173], v22 offset:11264
    ds_read_b64_tr_b16 v[174:175], v22 offset:11520
    s_waitcnt lgkmcnt(6)
    v_mfma_f32_16x16x32_bf16 v[24:27], v[160:163], v[96:99], v[24:27]
    ds_read_b64_tr_b16 v[176:177], v22 offset:12288
    ds_read_b64_tr_b16 v[178:179], v22 offset:12544
    s_waitcnt lgkmcnt(6)
    v_mfma_f32_16x16x32_bf16 v[24:27], v[164:167], v[100:103], v[24:27]
    ds_read_b64_tr_b16 v[180:181], v22 offset:13312
    ds_read_b64_tr_b16 v[182:183], v22 offset:13568
    s_waitcnt lgkmcnt(6)
    v_mfma_f32_16x16x32_bf16 v[24:27], v[168:171], v[104:107], v[24:27]
    ds_read_b64_tr_b16 v[184:185], v22 offset:14336
    ds_read_b64_tr_b16 v[186:187], v22 offset:14592
    s_waitcnt lgkmcnt(6)
    v_mfma_f32_16x16x32_bf16 v[24:27], v[172:175], v[108:111], v[24:27]
    ds_read_b64_tr_b16 v[188:189], v22 offset:15360
    ds_read_b64_tr_b16 v[190:191], v22 offset:15616
    s_waitcnt lgkmcnt(6)
    v_mfma_f32_16x16x32_bf16 v[24:27], v[176:179], v[112:115], v[24:27]
    s_waitcnt lgkmcnt(4)
    v_mfma_f32_16x16x32_bf16 v[24:27], v[180:183], v[116:119], v[24:27]
    s_waitcnt lgkmcnt(2)
    v_mfma_f32_16x16x32_bf16 v[24:27], v[184:187], v[120:123], v[24:27]
    s_waitcnt lgkmcnt(0)
    v_mfma_f32_16x16x32_bf16 v[24:27], v[188:191], v[124:127], v[24:27]
    s_lshl_b32 s92, s58, 3
    s_add_u32 s92, s92, s57
    s_lshl_b32 s93, s92, 10
    s_add_u32 s93, s93, 65536
    v_and_b32 v8, 7, v1
    v_lshlrev_b32 v8, 3, v8
    s_lshl_b32 s4, s67, 10
    v_add_u32 v8, s4, v8
    ds_read_b64 v[10:11], v8
    v_mov_b32_dpp v28, v24 row_ror:8 row_mask:0xf bank_mask:0xf
    v_mov_b32_dpp v29, v25 row_ror:8 row_mask:0xf bank_mask:0xf
    v_mov_b32_dpp v30, v26 row_ror:8 row_mask:0xf bank_mask:0xf
    v_mov_b32_dpp v31, v27 row_ror:8 row_mask:0xf bank_mask:0xf
    s_waitcnt lgkmcnt(0)
    v_fma_f32 v24, -v10, v28, v24
    v_fma_f32 v25, -v10, v29, v25
    v_fma_f32 v26, -v10, v30, v26
    v_fma_f32 v27, -v10, v31, v27
    v_mul_f32 v24, v11, v24
    v_mul_f32 v25, v11, v25
    v_mul_f32 v26, v11, v26
    v_mul_f32 v27, v11, v27
    v_cvt_pk_bf16_f32 v32, v24, v25
    v_cvt_pk_bf16_f32 v33, v26, v27
    v_mov_b32 v34, v32
    v_mov_b32 v35, v33
    s_nop 0
    v_permlane32_swap_b32 v32, v34
    v_permlane32_swap_b32 v33, v35
    v_bfe_u32 v8, v1, 4, 1
    v_and_b32 v9, 7, v1
    v_lshlrev_b32 v9, 4, v9
    v_lshl_add_u32 v8, v8, 7, v9
    s_mov_b32 exec_lo, 0x00ff00ff
    s_mov_b32 exec_hi, 0
    buffer_store_dwordx4 v[32:35], v8, s[48:51], s93 offen sc1
    s_mov_b64 exec, -1
    v_dot2_f32_bf16 v12, v32, v32, 0
    v_dot2_f32_bf16 v12, v33, v33, v12
    v_dot2_f32_bf16 v12, v34, v34, v12
    v_dot2_f32_bf16 v12, v35, v35, v12
    s_nop 2
    v_mov_b32 v13, v12
    s_nop 1
    v_permlane16_swap_b32 v12, v13
    v_add_f32 v12, v12, v13
    v_and_b32 v13, 8, v1
    v_cmp_eq_u32 vcc, 0, v13
    s_nop 1
    v_cndmask_b32 v12, 0, v12, vcc
    s_nop 1
    v_max_f32_dpp v12, v12, v12 row_ror:8 row_mask:0xf bank_mask:0xf
    s_nop 1
    v_max_f32_dpp v12, v12, v12 row_ror:4 row_mask:0xf bank_mask:0xf
    s_nop 1
    v_max_f32_dpp v12, v12, v12 row_ror:2 row_mask:0xf bank_mask:0xf
    s_nop 1
    v_max_f32_dpp v12, v12, v12 row_ror:1 row_mask:0xf bank_mask:0xf
    s_nop 0
    v_readlane_b32 s94, v12, 0
    s_nop 0
    s_add_u32 s94, s94, 8
    s_and_b32 s94, s94, 0xfffffff8
    s_or_b32 s94, s94, s91
    s_mov_b32 s3, s94
    s_mov_b32 s97, s92
    s_branch L_kv_fin
L_vwave:
    ds_read_b64_tr_b16 v[128:129], v22 offset:0
    ds_read_b64_tr_b16 v[130:131], v22 offset:256
    ds_read_b64_tr_b16 v[132:133], v22 offset:1024
    ds_read_b64_tr_b16 v[134:135], v22 offset:1280
    ds_read_b64_tr_b16 v[136:137], v22 offset:2048
    ds_read_b64_tr_b16 v[138:139], v22 offset:2304
    ds_read_b64_tr_b16 v[140:141], v22 offset:3072
    ds_read_b64_tr_b16 v[142:143], v22 offset:3328
    s_waitcnt lgkmcnt(6)
    v_mfma_f32_16x16x32_bf16 v[24:27], v[64:67], v[128:131], 0
    ds_read_b64_tr_b16 v[144:145], v22 offset:4096
    ds_read_b64_tr_b16 v[146:147], v22 offset:4352
    s_waitcnt lgkmcnt(6)
    v_mfma_f32_16x16x32_bf16 v[24:27], v[68:71], v[132:135], v[24:27]
    ds_read_b64_tr_b16 v[148:149], v22 offset:5120
    ds_read_b64_tr_b16 v[150:151], v22 offset:5376
    s_waitcnt lgkmcnt(6)
    v_mfma_f32_16x16x32_bf16 v[24:27], v[72:75], v[136:139], v[24:27]
    ds_read_b64_tr_b16 v[152:153], v22 offset:6144
    ds_read_b64_tr_b16 v[154:155], v22 offset:6400
    s_waitcnt lgkmcnt(6)
    v_mfma_f32_16x16x32_bf16 v[24:27], v[76:79], v[140:143], v[24:27]
    ds_read_b64_tr_b16 v[156:157], v22 offset:7168
    ds_read_b64_tr_b16 v[158:159], v22 offset:7424
    s_waitcnt lgkmcnt(6)
    v_mfma_f32_16x16x32_bf16 v[24:27], v[80:83], v[144:147], v[24:27]
    ds_read_b64_tr_b16 v[160:161], v22 offset:8192
    ds_read_b64_tr_b16 v[162:163], v22 offset:8448
    s_waitcnt lgkmcnt(6)
    v_mfma_f32_16x16x32_bf16 v[24:27], v[84:87], v[148:151], v[24:27]
    ds_read_b64_tr_b16 v[164:165], v22 offset:9216
    ds_read_b64_tr_b16 v[166:167], v22 offset:9472
    s_waitcnt lgkmcnt(6)
    v_mfma_f32_16x16x32_bf16 v[24:27], v[88:91], v[152:155], v[24:27]
    ds_read_b64_tr_b16 v[168:169], v22 offset:10240
    ds_read_b64_tr_b16 v[170:171], v22 offset:10496
    s_waitcnt lgkmcnt(6)
    v_mfma_f32_16x16x32_bf16 v[24:27], v[92:95], v[156:159], v[24:27]
    ds_read_b64_tr_b16 v[172:173], v22 offset:11264
    ds_read_b64_tr_b16 v[174:175], v22 offset:11520
    s_waitcnt lgkmcnt(6)
    v_mfma_f32_16x16x32_bf16 v[24:27], v[96:99], v[160:163], v[24:27]
    ds_read_b64_tr_b16 v[176:177], v22 offset:12288
    ds_read_b64_tr_b16 v[178:179], v22 offset:12544
    s_waitcnt lgkmcnt(6)
    v_mfma_f32_16x16x32_bf16 v[24:27], v[100:103], v[164:167], v[24:27]
    ds_read_b64_tr_b16 v[180:181], v22 offset:13312
    ds_read_b64_tr_b16 v[182:183], v22 offset:13568
    s_waitcnt lgkmcnt(6)
    v_mfma_f32_16x16x32_bf16 v[24:27], v[104:107], v[168:171], v[24:27]
    ds_read_b64_tr_b16 v[184:185], v22 offset:14336
    ds_read_b64_tr_b16 v[186:187], v22 offset:14592
    s_waitcnt lgkmcnt(6)
    v_mfma_f32_16x16x32_bf16 v[24:27], v[108:111], v[172:175], v[24:27]
    ds_read_b64_tr_b16 v[188:189], v22 offset:15360
    ds_read_b64_tr_b16 v[190:191], v22 offset:15616
    s_waitcnt lgkmcnt(6)
    v_mfma_f32_16x16x32_bf16 v[24:27], v[112:115], v[176:179], v[24:27]
    s_waitcnt lgkmcnt(4)
    v_mfma_f32_16x16x32_bf16 v[24:27], v[116:119], v[180:183], v[24:27]
    s_waitcnt lgkmcnt(2)
    v_mfma_f32_16x16x32_bf16 v[24:27], v[120:123], v[184:187], v[24:27]
    s_waitcnt lgkmcnt(0)
    v_mfma_f32_16x16x32_bf16 v[24:27], v[124:127], v[188:191], v[24:27]
    s_lshl_b32 s92, s58, 3
    s_add_u32 s92, s92, s57
    s_lshl_b32 s93, s92, 10
    s_add_u32 s93, s93, 65536
    v_bfe_u32 v8, v1, 4, 1
    v_lshlrev_b32 v8, 5, v8
    s_lshl_b32 s4, s67, 10
    s_add_u32 s4, s4, 8192
    v_add_u32 v8, s4, v8
    ds_read_b128 v[12:15], v8
    ds_read_b128 v[36:39], v8 offset:16
    v_and_b32 v9, 7, v1
    v_lshlrev_b32 v9, 3, v9
    v_add_u32 v40, s4, v9
    ds_read_b64 v[42:43], v40
    v_mov_b32 v28, v24
    v_mov_b32 v29, v24
    s_nop 1
    v_permlane32_swap_b32 v28, v29
    s_waitcnt lgkmcnt(0)
    v_fma_f32 v24, -v12, v29, v24
    v_fma_f32 v25, -v14, v29, v25
    v_fma_f32 v26, -v36, v29, v26
    v_fma_f32 v27, -v38, v29, v27
    v_mul_f32 v24, v13, v24
    v_mul_f32 v25, v15, v25
    v_mul_f32 v26, v37, v26
    v_mul_f32 v27, v39, v27
    v_cvt_pk_bf16_f32 v32, v24, v25
    v_cvt_pk_bf16_f32 v33, v26, v27
    v_mov_b32 v34, v32
    v_mov_b32 v35, v33
    s_nop 0
    v_permlane16_swap_b32 v32, v34
    v_permlane16_swap_b32 v33, v35
    v_add_u32 v8, 256, v2
    s_mov_b64 exec, 0xffff
    buffer_store_dwordx4 v[32:35], v8, s[48:51], s93 offen sc1
    s_mov_b64 exec, 0xff
    v_add_u32 v9, 512, v9
    buffer_store_dwordx2 v[42:43], v9, s[48:51], s93 offen sc1
    s_mov_b64 exec, -1
    s_mov_b32 s97, s92
L_kv_fin:
    v_xor_b32 v17, 64, v16
    s_lshl_b32 s94, s67, 13
    s_lshl_b32 s95, s56, 7
    s_add_u32 s94, s94, s95
    s_add_u32 s94, s94, s68
    s_lshl_b32 s95, s56, 13
    s_lshl_b32 s96, s67, 10
    s_add_u32 m0, s95, s96
    s_nop 0
    buffer_load_dwordx4 v17, s[8:11], s94 offen lds
    v_bfe_u32 v8, v1, 2, 2
    v_lshrrev_b32 v9, 5, v1
    v_lshl_add_u32 v9, v9, 3, v8
    v_lshlrev_b32 v9, 7, v9
    v_bfe_u32 v10, v1, 4, 1
    v_lshlrev_b32 v10, 5, v10
    v_and_b32 v11, 3, v1
    v_lshl_add_u32 v10, v11, 3, v10
    s_lshl_b32 s92, s62, 6
    v_add_u32 v10, s92, v10
    v_bfe_u32 v11, v1, 3, 1
    v_lshlrev_b32 v11, 6, v11
    v_xor_b32 v10, v10, v11
    v_add_u32 v9, v9, v10
    s_and_b32 s92, s90, s63
    s_lshl_b32 s92, s92, 15
    s_add_u32 s92, s92, 98304
    v_add_u32 v20, s92, v9
    v_and_b32 v8, 31, v1
    v_bfe_u32 v9, v1, 1, 3
    v_lshrrev_b32 v10, 5, v1
    v_xor_b32 v9, v9, v10
    v_lshlrev_b32 v9, 4, v9
    v_lshl_add_u32 v8, v8, 7, v9
    s_lshl_b32 s93, s63, 12
    v_add_u32 v22, s93, v8
    v_xor_b32 v23, 32, v22
    v_xor_b32 v24, 64, v22
    v_xor_b32 v25, 96, v22
    v_bfe_u32 v59, v1, 3, 2
    v_lshlrev_b32 v59, 10, v59
    v_and_b32 v13, 7, v1
    v_lshl_or_b32 v59, v13, 4, v59
    v_lshrrev_b32 v13, 5, v1
    v_lshl_or_b32 v59, v13, 7, v59
    v_lshrrev_b32 v60, 4, v1
    v_lshlrev_b32 v60, 10, v60
    v_and_b32 v13, 15, v1
    v_lshl_or_b32 v60, v13, 4, v60
    v_add_u32 v60, 256, v60
    s_lshr_b32 s64, s2, 3
    s_lshl_b32 s64, s64, 1
    v_bfe_u32 v12, v1, 3, 2
    v_and_b32 v13, 7, v1
    v_lshlrev_b32 v13, 3, v13
    v_lshl_add_u32 v12, v12, 10, v13
    s_lshl_b32 s92, s58, 3
    s_lshl_b32 s93, s63, 2
    s_add_u32 s92, s92, s93
    s_lshl_b32 s92, s92, 10
    s_add_u32 s65, s92, 66048
    s_mov_b32 s66, 4096
    s_waitcnt vmcnt(1) lgkmcnt(0)
    s_add_u32 s94, s60, 1
    s_lshl_b32 s92, s97, 4
    s_add_u32 s92, s92, 4096
    v_mov_b32 v8, s94
    v_mov_b32 v9, s3
    v_mov_b32 v10, 0
    s_mov_b64 exec, 1
    s_cmp_eq_u32 s56, 1
    s_cbranch_scc1 L_flagv
    buffer_store_dwordx2 v[8:9], v10, s[48:51], s92 offen sc1
    s_branch L_flagd
L_flagv:
    buffer_store_dword v8, v10, s[48:51], s92 offen offset:8 sc1
L_flagd:
    s_mov_b64 exec, -1
    s_waitcnt vmcnt(1)
    s_branch L_b2
L_kv_done:
    v_bfe_u32 v8, v1, 2, 2
    v_lshrrev_b32 v9, 5, v1
    v_lshl_add_u32 v9, v9, 3, v8
    v_lshlrev_b32 v9, 7, v9
    v_bfe_u32 v10, v1, 4, 1
    v_lshlrev_b32 v10, 5, v10
    v_and_b32 v11, 3, v1
    v_lshl_add_u32 v10, v11, 3, v10
    s_lshl_b32 s92, s62, 6
    v_add_u32 v10, s92, v10
    v_bfe_u32 v11, v1, 3, 1
    v_lshlrev_b32 v11, 6, v11
    v_xor_b32 v10, v10, v11
    v_add_u32 v9, v9, v10
    s_and_b32 s92, s90, s63
    s_lshl_b32 s92, s92, 15
    s_add_u32 s92, s92, 98304
    v_add_u32 v20, s92, v9
    v_and_b32 v8, 31, v1
    v_bfe_u32 v9, v1, 1, 3
    v_lshrrev_b32 v10, 5, v1
    v_xor_b32 v9, v9, v10
    v_lshlrev_b32 v9, 4, v9
    v_lshl_add_u32 v8, v8, 7, v9
    s_lshl_b32 s93, s63, 12
    v_add_u32 v22, s93, v8
    v_xor_b32 v23, 32, v22
    v_xor_b32 v24, 64, v22
    v_xor_b32 v25, 96, v22
    v_bfe_u32 v59, v1, 3, 2
    v_lshlrev_b32 v59, 10, v59
    v_and_b32 v13, 7, v1
    v_lshl_or_b32 v59, v13, 4, v59
    v_lshrrev_b32 v13, 5, v1
    v_lshl_or_b32 v59, v13, 7, v59
    v_lshrrev_b32 v60, 4, v1
    v_lshlrev_b32 v60, 10, v60
    v_and_b32 v13, 15, v1
    v_lshl_or_b32 v60, v13, 4, v60
    v_add_u32 v60, 256, v60
    s_lshr_b32 s64, s2, 3
    s_lshl_b32 s64, s64, 1
    v_bfe_u32 v12, v1, 3, 2
    v_and_b32 v13, 7, v1
    v_lshlrev_b32 v13, 3, v13
    v_lshl_add_u32 v12, v12, 10, v13
    s_lshl_b32 s92, s58, 3
    s_lshl_b32 s93, s63, 2
    s_add_u32 s92, s92, s93
    s_lshl_b32 s92, s92, 10
    s_add_u32 s65, s92, 66048
    s_mov_b32 s66, 4096
    s_waitcnt vmcnt(0)
L_b2:
    s_barrier
    s_add_u32 s3, s60, 1
    s_cmp_eq_u32 s90, 0
    s_cbranch_scc0 L_hwave
    ds_read_b64_tr_b16 v[64:65], v20 offset:0
    ds_read_b64_tr_b16 v[66:67], v20 offset:512
    ds_read_b128 v[128:131], v22 offset:0
    ds_read_b64_tr_b16 v[68:69], v20 offset:2048
    ds_read_b64_tr_b16 v[70:71], v20 offset:2560
    ds_read_b128 v[132:135], v23 offset:0
    ds_read_b64_tr_b16 v[72:73], v20 offset:4096
    ds_read_b64_tr_b16 v[74:75], v20 offset:4608
    ds_read_b128 v[136:139], v24 offset:0
    ds_read_b64_tr_b16 v[76:77], v20 offset:6144
    ds_read_b64_tr_b16 v[78:79], v20 offset:6656
    ds_read_b128 v[140:143], v25 offset:0
    s_waitcnt lgkmcnt(9)
    v_mfma_f32_32x32x16_bf16 v[32:47], v[64:67], v[128:131], 0
    ds_read_b64_tr_b16 v[80:81], v20 offset:8192
    ds_read_b64_tr_b16 v[82:83], v20 offset:8704
    ds_read_b128 v[144:147], v22 offset:8192
    s_waitcnt lgkmcnt(9)
    v_mfma_f32_32x32x16_bf16 v[32:47], v[68:71], v[132:135], v[32:47]
    ds_read_b64_tr_b16 v[64:65], v20 offset:10240
    ds_read_b64_tr_b16 v[66:67], v20 offset:10752
    ds_read_b128 v[128:131], v23 offset:8192
    s_waitcnt lgkmcnt(9)
    v_mfma_f32_32x32x16_bf16 v[32:47], v[72:75], v[136:139], v[32:47]
    ds_read_b64_tr_b16 v[68:69], v20 offset:12288
    ds_read_b64_tr_b16 v[70:71], v20 offset:12800
    ds_read_b128 v[132:135], v24 offset:8192
    s_waitcnt lgkmcnt(9)
    v_mfma_f32_32x32x16_bf16 v[32:47], v[76:79], v[140:143], v[32:47]
    ds_read_b64_tr_b16 v[72:73], v20 offset:14336
    ds_read_b64_tr_b16 v[74:75], v20 offset:14848
    ds_read_b128 v[136:139], v25 offset:8192
    s_waitcnt lgkmcnt(9)
    v_mfma_f32_32x32x16_bf16 v[32:47], v[80:83], v[144:147], v[32:47]
    ds_read_b64_tr_b16 v[76:77], v20 offset:16384
    ds_read_b64_tr_b16 v[78:79], v20 offset:16896
    ds_read_b128 v[140:143], v22 offset:16384
    s_waitcnt lgkmcnt(9)
    v_mfma_f32_32x32x16_bf16 v[32:47], v[64:67], v[128:131], v[32:47]
    ds_read_b64_tr_b16 v[80:81], v20 offset:18432
    ds_read_b64_tr_b16 v[82:83], v20 offset:18944
    ds_read_b128 v[144:147], v23 offset:16384
    s_waitcnt lgkmcnt(9)
    v_mfma_f32_32x32x16_bf16 v[32:47], v[68:71], v[132:135], v[32:47]
    ds_read_b64_tr_b16 v[64:65], v20 offset:20480
    ds_read_b64_tr_b16 v[66:67], v20 offset:20992
    ds_read_b128 v[128:131], v24 offset:16384
    s_waitcnt lgkmcnt(9)
    v_mfma_f32_32x32x16_bf16 v[32:47], v[72:75], v[136:139], v[32:47]
    ds_read_b64_tr_b16 v[68:69], v20 offset:22528
    ds_read_b64_tr_b16 v[70:71], v20 offset:23040
    ds_read_b128 v[132:135], v25 offset:16384
    s_waitcnt lgkmcnt(9)
    v_mfma_f32_32x32x16_bf16 v[32:47], v[76:79], v[140:143], v[32:47]
    ds_read_b64_tr_b16 v[72:73], v20 offset:24576
    ds_read_b64_tr_b16 v[74:75], v20 offset:25088
    ds_read_b128 v[136:139], v22 offset:24576
    s_waitcnt lgkmcnt(9)
    v_mfma_f32_32x32x16_bf16 v[32:47], v[80:83], v[144:147], v[32:47]
    ds_read_b64_tr_b16 v[76:77], v20 offset:26624
    ds_read_b64_tr_b16 v[78:79], v20 offset:27136
    ds_read_b128 v[140:143], v23 offset:24576
    s_waitcnt lgkmcnt(9)
    v_mfma_f32_32x32x16_bf16 v[32:47], v[64:67], v[128:131], v[32:47]
    ds_read_b64_tr_b16 v[80:81], v20 offset:28672
    ds_read_b64_tr_b16 v[82:83], v20 offset:29184
    ds_read_b128 v[144:147], v24 offset:24576
    s_waitcnt lgkmcnt(9)
    v_mfma_f32_32x32x16_bf16 v[32:47], v[68:71], v[132:135], v[32:47]
    ds_read_b64_tr_b16 v[64:65], v20 offset:30720
    ds_read_b64_tr_b16 v[66:67], v20 offset:31232
    ds_read_b128 v[128:131], v25 offset:24576
    s_waitcnt lgkmcnt(9)
    v_mfma_f32_32x32x16_bf16 v[32:47], v[72:75], v[136:139], v[32:47]
    ds_read_b64_tr_b16 v[68:69], v20 offset:32768
    ds_read_b64_tr_b16 v[70:71], v20 offset:33280
    ds_read_b128 v[132:135], v22 offset:32768
    s_waitcnt lgkmcnt(9)
    v_mfma_f32_32x32x16_bf16 v[32:47], v[76:79], v[140:143], v[32:47]
    ds_read_b64_tr_b16 v[72:73], v20 offset:34816
    ds_read_b64_tr_b16 v[74:75], v20 offset:35328
    ds_read_b128 v[136:139], v23 offset:32768
    s_waitcnt lgkmcnt(9)
    v_mfma_f32_32x32x16_bf16 v[32:47], v[80:83], v[144:147], v[32:47]
    ds_read_b64_tr_b16 v[76:77], v20 offset:36864
    ds_read_b64_tr_b16 v[78:79], v20 offset:37376
    ds_read_b128 v[140:143], v24 offset:32768
    s_waitcnt lgkmcnt(9)
    v_mfma_f32_32x32x16_bf16 v[32:47], v[64:67], v[128:131], v[32:47]
    ds_read_b64_tr_b16 v[80:81], v20 offset:38912
    ds_read_b64_tr_b16 v[82:83], v20 offset:39424
    ds_read_b128 v[144:147], v25 offset:32768
    s_waitcnt lgkmcnt(9)
    v_mfma_f32_32x32x16_bf16 v[32:47], v[68:71], v[132:135], v[32:47]
    ds_read_b64_tr_b16 v[64:65], v20 offset:40960
    ds_read_b64_tr_b16 v[66:67], v20 offset:41472
    ds_read_b128 v[128:131], v22 offset:40960
    s_waitcnt lgkmcnt(9)
    v_mfma_f32_32x32x16_bf16 v[32:47], v[72:75], v[136:139], v[32:47]
    ds_read_b64_tr_b16 v[68:69], v20 offset:43008
    ds_read_b64_tr_b16 v[70:71], v20 offset:43520
    ds_read_b128 v[132:135], v23 offset:40960
    s_waitcnt lgkmcnt(9)
    v_mfma_f32_32x32x16_bf16 v[32:47], v[76:79], v[140:143], v[32:47]
    ds_read_b64_tr_b16 v[72:73], v20 offset:45056
    ds_read_b64_tr_b16 v[74:75], v20 offset:45568
    ds_read_b128 v[136:139], v24 offset:40960
    s_waitcnt lgkmcnt(9)
    v_mfma_f32_32x32x16_bf16 v[32:47], v[80:83], v[144:147], v[32:47]
    ds_read_b64_tr_b16 v[76:77], v20 offset:47104
    ds_read_b64_tr_b16 v[78:79], v20 offset:47616
    ds_read_b128 v[140:143], v25 offset:40960
    s_waitcnt lgkmcnt(9)
    v_mfma_f32_32x32x16_bf16 v[32:47], v[64:67], v[128:131], v[32:47]
    ds_read_b64_tr_b16 v[80:81], v20 offset:49152
    ds_read_b64_tr_b16 v[82:83], v20 offset:49664
    ds_read_b128 v[144:147], v22 offset:49152
    s_waitcnt lgkmcnt(9)
    v_mfma_f32_32x32x16_bf16 v[32:47], v[68:71], v[132:135], v[32:47]
    ds_read_b64_tr_b16 v[64:65], v20 offset:51200
    ds_read_b64_tr_b16 v[66:67], v20 offset:51712
    ds_read_b128 v[128:131], v23 offset:49152
    s_waitcnt lgkmcnt(9)
    v_mfma_f32_32x32x16_bf16 v[32:47], v[72:75], v[136:139], v[32:47]
    ds_read_b64_tr_b16 v[68:69], v20 offset:53248
    ds_read_b64_tr_b16 v[70:71], v20 offset:53760
    ds_read_b128 v[132:135], v24 offset:49152
    s_waitcnt lgkmcnt(9)
    v_mfma_f32_32x32x16_bf16 v[32:47], v[76:79], v[140:143], v[32:47]
    ds_read_b64_tr_b16 v[72:73], v20 offset:55296
    ds_read_b64_tr_b16 v[74:75], v20 offset:55808
    ds_read_b128 v[136:139], v25 offset:49152
    s_waitcnt lgkmcnt(9)
    v_mfma_f32_32x32x16_bf16 v[32:47], v[80:83], v[144:147], v[32:47]
    ds_read_b64_tr_b16 v[76:77], v20 offset:57344
    ds_read_b64_tr_b16 v[78:79], v20 offset:57856
    ds_read_b128 v[140:143], v22 offset:57344
    s_waitcnt lgkmcnt(9)
    v_mfma_f32_32x32x16_bf16 v[32:47], v[64:67], v[128:131], v[32:47]
    ds_read_b64_tr_b16 v[80:81], v20 offset:59392
    ds_read_b64_tr_b16 v[82:83], v20 offset:59904
    ds_read_b128 v[144:147], v23 offset:57344
    s_waitcnt lgkmcnt(9)
    v_mfma_f32_32x32x16_bf16 v[32:47], v[68:71], v[132:135], v[32:47]
    ds_read_b64_tr_b16 v[64:65], v20 offset:61440
    ds_read_b64_tr_b16 v[66:67], v20 offset:61952
    ds_read_b128 v[128:131], v24 offset:57344
    s_waitcnt lgkmcnt(9)
    v_mfma_f32_32x32x16_bf16 v[32:47], v[72:75], v[136:139], v[32:47]
    ds_read_b64_tr_b16 v[68:69], v20 offset:63488
    ds_read_b64_tr_b16 v[70:71], v20 offset:64000
    ds_read_b128 v[132:135], v25 offset:57344
    s_waitcnt lgkmcnt(9)
    v_mfma_f32_32x32x16_bf16 v[32:47], v[76:79], v[140:143], v[32:47]
    s_waitcnt lgkmcnt(6)
    v_mfma_f32_32x32x16_bf16 v[32:47], v[80:83], v[144:147], v[32:47]
    s_waitcnt lgkmcnt(3)
    v_mfma_f32_32x32x16_bf16 v[32:47], v[64:67], v[128:131], v[32:47]
    s_waitcnt lgkmcnt(0)
    v_mfma_f32_32x32x16_bf16 v[32:47], v[68:71], v[132:135], v[32:47]
    s_branch L_b3a
L_hwave:
    s_mov_b32 s74, 0x3f803f80
    s_mov_b32 s99, 0
    ds_read_b64_tr_b16 v[128:129], v20 offset:0
    ds_read_b64_tr_b16 v[130:131], v20 offset:512
    ds_read_b64_tr_b16 v[132:133], v20 offset:2048
    ds_read_b64_tr_b16 v[134:135], v20 offset:2560
    ds_read_b64_tr_b16 v[136:137], v20 offset:4096
    ds_read_b64_tr_b16 v[138:139], v20 offset:4608
    ds_read_b64_tr_b16 v[140:141], v20 offset:6144
    ds_read_b64_tr_b16 v[142:143], v20 offset:6656
    ds_read_b64_tr_b16 v[144:145], v20 offset:8192
    ds_read_b64_tr_b16 v[146:147], v20 offset:8704
    buffer_load_dwordx4 v[64:67], v2, s[48:51], s66 offen offset:0 sc1
    buffer_load_dwordx4 v[68:71], v2, s[48:51], s66 offen offset:1024 sc1
    buffer_load_dwordx4 v[72:75], v2, s[48:51], s66 offen offset:2048 sc1
    buffer_load_dwordx4 v[76:79], v2, s[48:51], s66 offen offset:3072 sc1
    s_waitcnt lgkmcnt(8)
    v_dot2_f32_bf16 v48, v128, s74, 0
    v_dot2_f32_bf16 v49, v129, s74, 0
    v_dot2_f32_bf16 v50, v130, s74, 0
    v_dot2_f32_bf16 v51, v131, s74, 0
    ds_read_b64_tr_b16 v[148:149], v20 offset:10240
    ds_read_b64_tr_b16 v[150:151], v20 offset:10752
    s_waitcnt lgkmcnt(8)
    v_dot2_f32_bf16 v48, v132, s74, v48
    v_dot2_f32_bf16 v49, v133, s74, v49
    v_dot2_f32_bf16 v50, v134, s74, v50
    v_dot2_f32_bf16 v51, v135, s74, v51
    ds_read_b64_tr_b16 v[128:129], v20 offset:12288
    ds_read_b64_tr_b16 v[130:131], v20 offset:12800
    s_waitcnt lgkmcnt(8)
    v_dot2_f32_bf16 v48, v136, s74, v48
    v_dot2_f32_bf16 v49, v137, s74, v49
    v_dot2_f32_bf16 v50, v138, s74, v50
    v_dot2_f32_bf16 v51, v139, s74, v51
    ds_read_b64_tr_b16 v[132:133], v20 offset:14336
    ds_read_b64_tr_b16 v[134:135], v20 offset:14848
    s_waitcnt lgkmcnt(8)
    v_dot2_f32_bf16 v48, v140, s74, v48
    v_dot2_f32_bf16 v49, v141, s74, v49
    v_dot2_f32_bf16 v50, v142, s74, v50
    v_dot2_f32_bf16 v51, v143, s74, v51
    ds_read_b64_tr_b16 v[136:137], v20 offset:16384
    ds_read_b64_tr_b16 v[138:139], v20 offset:16896
    s_waitcnt lgkmcnt(8)
    v_dot2_f32_bf16 v48, v144, s74, v48
    v_dot2_f32_bf16 v49, v145, s74, v49
    v_dot2_f32_bf16 v50, v146, s74, v50
    v_dot2_f32_bf16 v51, v147, s74, v51
    ds_read_b64_tr_b16 v[140:141], v20 offset:18432
    ds_read_b64_tr_b16 v[142:143], v20 offset:18944
    s_waitcnt lgkmcnt(8)
    v_dot2_f32_bf16 v48, v148, s74, v48
    v_dot2_f32_bf16 v49, v149, s74, v49
    v_dot2_f32_bf16 v50, v150, s74, v50
    v_dot2_f32_bf16 v51, v151, s74, v51
    ds_read_b64_tr_b16 v[144:145], v20 offset:20480
    ds_read_b64_tr_b16 v[146:147], v20 offset:20992
    s_waitcnt lgkmcnt(8)
    v_dot2_f32_bf16 v48, v128, s74, v48
    v_dot2_f32_bf16 v49, v129, s74, v49
    v_dot2_f32_bf16 v50, v130, s74, v50
    v_dot2_f32_bf16 v51, v131, s74, v51
    ds_read_b64_tr_b16 v[148:149], v20 offset:22528
    ds_read_b64_tr_b16 v[150:151], v20 offset:23040
    s_waitcnt lgkmcnt(8)
    v_dot2_f32_bf16 v48, v132, s74, v48
    v_dot2_f32_bf16 v49, v133, s74, v49
    v_dot2_f32_bf16 v50, v134, s74, v50
    v_dot2_f32_bf16 v51, v135, s74, v51
    ds_read_b64_tr_b16 v[128:129], v20 offset:24576
    ds_read_b64_tr_b16 v[130:131], v20 offset:25088
    s_cmp_eq_u32 s99, 1
    s_cbranch_scc1 L_kv_have
    s_mov_b32 s98, 200000
L_poll_kv:
    s_waitcnt vmcnt(0)
    v_xor_b32 v80, s3, v64
    v_xor_b32 v81, s3, v66
    v_or_b32 v80, v80, v81
    v_xor_b32 v81, s3, v68
    v_or_b32 v80, v80, v81
    v_xor_b32 v81, s3, v70
    v_or_b32 v80, v80, v81
    v_xor_b32 v81, s3, v72
    v_or_b32 v80, v80, v81
    v_xor_b32 v81, s3, v74
    v_or_b32 v80, v80, v81
    v_xor_b32 v81, s3, v76
    v_or_b32 v80, v80, v81
    v_xor_b32 v81, s3, v78
    v_or_b32 v80, v80, v81
    v_cmp_ne_u32 vcc, 0, v80
    s_nop 0
    s_cbranch_vccz L_pollok_kv
    s_sub_u32 s98, s98, 1
    s_cmp_eq_u32 s98, 0
    s_cbranch_scc1 L_pollok_kv
    s_sleep 2
    buffer_load_dwordx4 v[64:67], v2, s[48:51], s66 offen offset:0 sc1
    buffer_load_dwordx4 v[68:71], v2, s[48:51], s66 offen offset:1024 sc1
    buffer_load_dwordx4 v[72:75], v2, s[48:51], s66 offen offset:2048 sc1
    buffer_load_dwordx4 v[76:79], v2, s[48:51], s66 offen offset:3072 sc1
    s_branch L_poll_kv
L_pollok_kv:
    buffer_load_dwordx2 v[10:11], v12, s[48:51], s65 offen sc1
    s_add_u32 s96, s56, 28
    s_add_u32 s94, s96, s64
    s_and_b32 s94, s94, 63
    s_lshl_b32 s94, s94, 12
    s_add_u32 s94, s94, 65536
    s_lshl_b32 s95, s96, 11
    s_mov_b32 m0, s95
    s_nop 0
    buffer_load_dwordx4 v59, s[48:51], s94 offen sc1 lds
    s_add_u32 m0, s95, 1024
    s_nop 0
    buffer_load_dwordx4 v60, s[48:51], s94 offen sc1 lds
    s_add_u32 s96, s96, 4
    s_add_u32 s94, s96, s64
    s_and_b32 s94, s94, 63
    s_lshl_b32 s94, s94, 12
    s_add_u32 s94, s94, 65536
    s_lshl_b32 s95, s96, 11
    s_mov_b32 m0, s95
    s_nop 0
    buffer_load_dwordx4 v59, s[48:51], s94 offen sc1 lds
    s_add_u32 m0, s95, 1024
    s_nop 0
    buffer_load_dwordx4 v60, s[48:51], s94 offen sc1 lds
    s_add_u32 s96, s96, 4
    s_add_u32 s94, s96, s64
    s_and_b32 s94, s94, 63
    s_lshl_b32 s94, s94, 12
    s_add_u32 s94, s94, 65536
    s_lshl_b32 s95, s96, 11
    s_mov_b32 m0, s95
    s_nop 0
    buffer_load_dwordx4 v59, s[48:51], s94 offen sc1 lds
    s_add_u32 m0, s95, 1024
    s_nop 0
    buffer_load_dwordx4 v60, s[48:51], s94 offen sc1 lds
    s_add_u32 s96, s96, 4
    s_add_u32 s94, s96, s64
    s_and_b32 s94, s94, 63
    s_lshl_b32 s94, s94, 12
    s_add_u32 s94, s94, 65536
    s_lshl_b32 s95, s96, 11
    s_mov_b32 m0, s95
    s_nop 0
    buffer_load_dwordx4 v59, s[48:51], s94 offen sc1 lds
    s_add_u32 m0, s95, 1024
    s_nop 0
    buffer_load_dwordx4 v60, s[48:51], s94 offen sc1 lds
L_kv_have:
    s_waitcnt lgkmcnt(8)
    v_dot2_f32_bf16 v48, v136, s74, v48
    v_dot2_f32_bf16 v49, v137, s74, v49
    v_dot2_f32_bf16 v50, v138, s74, v50
    v_dot2_f32_bf16 v51, v139, s74, v51
    ds_read_b64_tr_b16 v[132:133], v20 offset:26624
    ds_read_b64_tr_b16 v[134:135], v20 offset:27136
    s_waitcnt lgkmcnt(8)
    v_dot2_f32_bf16 v48, v140, s74, v48
    v_dot2_f32_bf16 v49, v141, s74, v49
    v_dot2_f32_bf16 v50, v142, s74, v50
    v_dot2_f32_bf16 v51, v143, s74, v51
    ds_read_b64_tr_b16 v[136:137], v20 offset:28672
    ds_read_b64_tr_b16 v[138:139], v20 offset:29184
    s_waitcnt lgkmcnt(8)
    v_dot2_f32_bf16 v48, v144, s74, v48
    v_dot2_f32_bf16 v49, v145, s74, v49
    v_dot2_f32_bf16 v50, v146, s74, v50
    v_dot2_f32_bf16 v51, v147, s74, v51
    ds_read_b64_tr_b16 v[140:141], v20 offset:30720
    ds_read_b64_tr_b16 v[142:143], v20 offset:31232
    s_waitcnt lgkmcnt(8)
    v_dot2_f32_bf16 v48, v148, s74, v48
    v_dot2_f32_bf16 v49, v149, s74, v49
    v_dot2_f32_bf16 v50, v150, s74, v50
    v_dot2_f32_bf16 v51, v151, s74, v51
    s_waitcnt lgkmcnt(6)
    v_dot2_f32_bf16 v48, v128, s74, v48
    v_dot2_f32_bf16 v49, v129, s74, v49
    v_dot2_f32_bf16 v50, v130, s74, v50
    v_dot2_f32_bf16 v51, v131, s74, v51
    s_waitcnt lgkmcnt(4)
    v_dot2_f32_bf16 v48, v132, s74, v48
    v_dot2_f32_bf16 v49, v133, s74, v49
    v_dot2_f32_bf16 v50, v134, s74, v50
    v_dot2_f32_bf16 v51, v135, s74, v51
    s_waitcnt lgkmcnt(2)
    v_dot2_f32_bf16 v48, v136, s74, v48
    v_dot2_f32_bf16 v49, v137, s74, v49
    v_dot2_f32_bf16 v50, v138, s74, v50
    v_dot2_f32_bf16 v51, v139, s74, v51
    s_waitcnt lgkmcnt(0)
    v_dot2_f32_bf16 v48, v140, s74, v48
    v_dot2_f32_bf16 v49, v141, s74, v49
    v_dot2_f32_bf16 v50, v142, s74, v50
    v_dot2_f32_bf16 v51, v143, s74, v51
    s_nop 0
    v_add_f32 v48, v48, v49
    s_nop 0
    v_add_f32 v50, v50, v51
    v_add_f32 v48, v48, v50
    v_mov_b32 v9, v48
    s_nop 1
    v_permlane32_swap_b32 v48, v9
    v_add_f32 v48, v48, v9
L_b3a:
    s_barrier
    s_cmp_eq_u32 s90, 0
    s_cbranch_scc0 L_p2h
    buffer_load_dwordx2 v[10:11], v12, s[48:51], s65 offen sc1
    s_lshl_b32 s92, s56, 11
    s_add_u32 s92, s92, 151552
    v_add_u32 v8, s92, v2
    s_nop 3
    ds_write_b128 v8, v[40:43]
    ds_write_b128 v8, v[44:47] offset:1024
    s_branch L_p2j
L_p2h:
    v_and_b32 v9, 31, v1
    s_lshl_b32 s92, s63, 1
    s_add_u32 s92, s92, s62
    s_lshl_b32 s92, s92, 7
    s_add_u32 s92, s92, 160768
    v_lshlrev_b32 v9, 2, v9
    v_add_u32 v9, s92, v9
    ds_write_b32 v9, v48
L_p2j:
    s_waitcnt lgkmcnt(0)
    s_barrier
    v_lshrrev_b32 v9, 5, v1
    v_lshlrev_b32 v9, 4, v9
    s_lshl_b32 s92, s62, 7
    s_lshl_b32 s93, s90, 6
    s_add_u32 s92, s92, s93
    s_add_u32 s92, s92, 160768
    v_add_u32 v9, s92, v9
    ds_read_b128 v[84:87], v9 offset:0
    ds_read_b128 v[88:91], v9 offset:32
    ds_read_b128 v[92:95], v9 offset:256
    ds_read_b128 v[96:99], v9 offset:288
    s_cmp_eq_u32 s90, 0
    s_cbranch_scc1 L_p2k
    s_lshl_b32 s92, s56, 11
    s_add_u32 s92, s92, 143360
    v_add_u32 v8, s92, v2
    ds_read_b128 v[32:35], v8
    ds_read_b128 v[36:39], v8 offset:1024
L_p2k:
    s_waitcnt lgkmcnt(0)
    v_add_f32 v40, v84, v92
    v_add_f32 v41, v85, v93
    v_add_f32 v42, v86, v94
    v_add_f32 v43, v87, v95
    v_add_f32 v44, v88, v96
    v_add_f32 v45, v89, v97
    v_add_f32 v46, v90, v98
    v_add_f32 v47, v91, v99
    s_cmp_eq_u32 s90, 0
    s_cbranch_scc1 L_p2w
    s_waitcnt vmcnt(8)
    s_branch L_p2x
L_p2w:
    s_waitcnt vmcnt(0)
L_p2x:
    v_mul_f32 v11, 0x3eb8aa3b, v11
    v_fma_f32 v32, -v10, v40, v32
    v_fma_f32 v33, -v10, v41, v33
    v_fma_f32 v34, -v10, v42, v34
    v_fma_f32 v35, -v10, v43, v35
    v_fma_f32 v36, -v10, v44, v36
    v_fma_f32 v37, -v10, v45, v37
    v_fma_f32 v38, -v10, v46, v38
    v_fma_f32 v39, -v10, v47, v39
    v_mul_f32 v32, v11, v32
    v_mul_f32 v33, v11, v33
    v_mul_f32 v34, v11, v34
    v_mul_f32 v35, v11, v35
    v_mul_f32 v36, v11, v36
    v_mul_f32 v37, v11, v37
    v_mul_f32 v38, v11, v38
    v_mul_f32 v39, v11, v39
    v_cvt_pk_bf16_f32 v4, v32, v33
    v_cvt_pk_bf16_f32 v5, v34, v35
    v_cvt_pk_bf16_f32 v6, v36, v37
    v_cvt_pk_bf16_f32 v7, v38, v39
    v_dot2_f32_bf16 v12, v4, v4, 0
    v_dot2_f32_bf16 v12, v5, v5, v12
    v_dot2_f32_bf16 v12, v6, v6, v12
    v_dot2_f32_bf16 v12, v7, v7, v12
    s_nop 2
    v_mov_b32 v13, v12
    s_nop 1
    v_permlane32_swap_b32 v12, v13
    v_add_f32 v12, v12, v13
    v_sqrt_f32 v12, v12
    s_nop 0
    v_mul_f32 v12, 0x3f810000, v12
    s_lshl_b32 s92, s2, 3
    s_add_u32 s92, s92, s56
    s_cmp_lt_u32 s92, 256
    s_cbranch_scc1 L_wt_wo_2
    s_cmp_lt_u32 s92, 1152
    s_cbranch_scc1 L_wt_w1_1
    s_sub_u32 s92, s92, 1152
    s_mul_i32 s93, s92, 9363
    s_lshr_b32 s93, s93, 20
    s_mul_i32 s94, s93, 112
    s_sub_u32 s94, s92, s94
    s_mov_b32 s52, s32
    s_mov_b32 s53, s33
    s_mov_b32 s54, s34
    s_mov_b32 s55, s35
    s_mov_b32 s96, 1024
    s_mul_i32 s88, s93, 224
    s_add_u32 s88, s88, s94
    s_lshl_b32 s88, s88, 10
    s_add_u32 s88, s88, 14942208
    s_mov_b32 s89, 114688
    s_branch L_wt_go_3
L_wt_w1_1:
    s_sub_u32 s92, s92, 256
    s_lshr_b32 s93, s92, 5
    s_and_b32 s94, s92, 31
    s_mov_b32 s52, s28
    s_mov_b32 s53, s29
    s_mov_b32 s54, s30
    s_mov_b32 s55, s31
    s_mov_b32 s96, 3584
    s_lshl_b32 s88, s93, 6
    s_add_u32 s88, s88, s94
    s_lshl_b32 s88, s88, 10
    s_add_u32 s88, s88, 13107200
    s_mov_b32 s89, 32768
    s_branch L_wt_go_3
L_wt_wo_2:
    s_lshr_b32 s93, s92, 5
    s_and_b32 s94, s92, 31
    s_mov_b32 s52, s24
    s_mov_b32 s53, s25
    s_mov_b32 s54, s26
    s_mov_b32 s55, s27
    s_mov_b32 s96, 1024
    s_lshl_b32 s88, s93, 6
    s_add_u32 s88, s88, s94
    s_lshl_b32 s88, s88, 10
    s_add_u32 s88, s88, 12582912
    s_mov_b32 s89, 32768
L_wt_go_3:
    s_mul_i32 s94, s94, s96
    s_lshl_b32 s94, s94, 4
    s_lshl_b32 s93, s93, 7
    s_add_u32 s94, s94, s93
    v_lshrrev_b32 v16, 3, v1
    v_mul_lo_u32 v16, v16, s96
    v_and_b32 v17, 7, v1
    v_bfe_u32 v18, v1, 4, 1
    v_lshlrev_b32 v18, 2, v18
    v_xor_b32 v17, v17, v18
    v_lshl_add_u32 v16, v17, 4, v16
    s_xor_b32 s92, s56, 1
    s_lshl_b32 s92, s92, 11
    s_add_u32 s92, s92, 135168
    s_mov_b32 m0, s92
    s_nop 0
    buffer_load_dwordx4 v16, s[52:55], s94 offen lds
    s_lshl_b32 s93, s96, 3
    s_add_u32 s94, s94, s93
    s_add_u32 s92, s92, 1024
    s_mov_b32 m0, s92
    s_nop 0
    buffer_load_dwordx4 v16, s[52:55], s94 offen lds
    s_cmp_eq_u32 s56, 7
    s_cbranch_scc0 L_nobc
    v_and_b32 v80, -8, v65
    v_and_b32 v81, -8, v69
    v_max_f32 v80, v80, v81
    v_and_b32 v81, -8, v73
    v_max_f32 v80, v80, v81
    v_and_b32 v81, -8, v77
    v_max_f32 v80, v80, v81
    s_lshr_b32 s93, s58, 3
    v_mov_b32 v82, v65
    s_cmp_eq_u32 s93, 1
    s_cselect_b64 vcc, -1, 0
    v_cndmask_b32 v82, v82, v69, vcc
    s_cmp_eq_u32 s93, 2
    s_cselect_b64 vcc, -1, 0
    v_cndmask_b32 v82, v82, v73, vcc
    s_cmp_eq_u32 s93, 3
    s_cselect_b64 vcc, -1, 0
    v_cndmask_b32 v82, v82, v77, vcc
    v_xor_b32 v82, s91, v82
    v_and_b32 v82, 7, v82
    v_cmp_ne_u32 vcc, 0, v82
    s_and_b32 s92, s58, 7
    s_lshl_b32 s92, s92, 3
    s_lshr_b64 s[4:5], vcc, s92
    s_and_b32 s61, s4, 0xff
    v_max_f32_dpp v80, v80, v80 row_ror:8 row_mask:0xf bank_mask:0xf
    s_nop 1
    v_max_f32_dpp v80, v80, v80 row_ror:4 row_mask:0xf bank_mask:0xf
    s_nop 1
    v_max_f32_dpp v80, v80, v80 row_ror:2 row_mask:0xf bank_mask:0xf
    s_nop 1
    v_max_f32_dpp v80, v80, v80 row_ror:1 row_mask:0xf bank_mask:0xf
    v_mov_b32 v81, v80
    s_nop 1
    v_permlane16_swap_b32 v80, v81
    v_max_f32 v80, v80, v81
    v_mov_b32 v81, v80
    s_nop 1
    v_permlane32_swap_b32 v80, v81
    v_max_f32 v80, v80, v81
    v_sqrt_f32 v80, v80
    v_mov_b32 v81, s61
    v_mov_b32 v82, 159744
    s_mov_b64 exec, 1
    ds_write_b64 v82, v[80:81]
    s_mov_b64 exec, -1
L_nobc:
    v_mov_b32 v88, 0x3f803f80
    v_mov_b32 v89, v88
    v_mov_b32 v90, v88
    v_mov_b32 v91, v88
    v_mov_b32 v92, v88
    v_mov_b32 v93, v88
    v_mov_b32 v94, v88
    v_mov_b32 v95, v88
    v_mov_b32 v96, v88
    v_mov_b32 v97, v88
    v_mov_b32 v98, v88
    v_mov_b32 v99, v88
    v_mov_b32 v100, v88
    v_mov_b32 v101, v88
    v_mov_b32 v102, v88
    v_mov_b32 v103, v88
    v_mov_b32 v64, 0
    v_mov_b32 v65, 0
    v_mov_b32 v66, 0
    v_mov_b32 v67, 0
    v_mov_b32 v68, 0
    v_mov_b32 v69, 0
    v_mov_b32 v70, 0
    v_mov_b32 v71, 0
    v_mov_b32 v72, 0
    v_mov_b32 v73, 0
    v_mov_b32 v74, 0
    v_mov_b32 v75, 0
    v_mov_b32 v76, 0
    v_mov_b32 v77, 0
    v_mov_b32 v78, 0
    v_mov_b32 v79, 0
    v_mov_b32 v56, 0xdddddddd
    v_mov_b32 v104, v2
    v_add_u32 v106, 0x10000, v2
    v_and_b32 v3, 15, v1
    v_lshlrev_b32 v3, 4, v3
    v_lshrrev_b32 v61, 5, v1
    v_lshl_or_b32 v3, v61, 8, v3
    v_add_u32 v105, 1024, v3
    v_add_u32 v107, 0x10000, v105
    v_bfe_u32 v61, v1, 2, 2
    v_lshrrev_b32 v62, 5, v1
    v_lshl_add_u32 v62, v62, 2, v61
    v_lshlrev_b32 v62, 7, v62
    v_bfe_u32 v63, v1, 4, 1
    v_lshlrev_b32 v63, 5, v63
    v_and_b32 v61, 3, v1
    v_lshl_add_u32 v63, v61, 3, v63
    v_bfe_u32 v61, v1, 3, 1
    v_lshlrev_b32 v61, 6, v61
    v_xor_b32 v63, v63, v61
    v_add_u32 v62, v62, v63
    s_xor_b32 s92, s56, 1
    s_lshl_b32 s92, s92, 11
    s_add_u32 s92, s92, 135168
    v_add_u32 v108, s92, v62
    v_xor_b32 v109, 64, v108
    s_cmp_eq_u32 s56, 7
    s_cbranch_scc1 L_pa7_4
    s_mul_i32 s92, s57, 7
    s_add_u32 s92, s92, s56
    s_lshl_b32 s65, s92, 15
    s_add_u32 s65, s65, 13107200
    s_lshr_b32 s92, s92, 1
    s_lshl_b32 s92, s92, 5
    s_add_u32 s92, s92, 256
    s_branch L_pad_5
L_pa7_4:
    s_lshl_b32 s92, s57, 1
    s_add_u32 s92, s92, 1
    s_mul_i32 s92, s92, 112
    s_add_u32 s92, s92, 98
    s_lshl_b32 s65, s92, 10
    s_add_u32 s65, s65, 14942208
    s_mul_i32 s92, s57, 112
    s_add_u32 s92, s92, 1232
L_pad_5:
    s_lshl_b32 s93, s57, 5
    s_sub_u32 s93, s93, 32
    v_mov_b32 v57, s92
    v_mov_b32 v58, s93
    v_cmp_gt_u32 vcc, 32, v1
    s_nop 1
    v_cndmask_b32 v57, v58, v57, vcc
    v_add_u32 v57, v57, v1
    v_lshlrev_b32 v57, 2, v57
    v_add_u32 v57, 40960, v57
    s_mul_i32 s92, s57, 112
    s_mul_i32 s93, s56, 14
    s_add_u32 s92, s92, s93
    s_add_u32 s92, s92, 1152
    v_min_u32 v58, 13, v1
    v_add_u32 v58, s92, v58
    v_lshlrev_b32 v58, 2, v58
    v_add_u32 v58, 40960, v58
    s_mov_b32 s6, 0x0000ffff
    s_mov_b32 s7, 0x0000ffff
    v_mov_b32 v61, 159744
    s_waitcnt vmcnt(2) lgkmcnt(0)
    s_barrier
    s_cmp_eq_u32 s90, 0
    s_cbranch_scc1 L_clsA
    s_sub_u32 s67, s56, 4
    s_mov_b32 s98, 12
L_kvrest:
    s_add_u32 s96, s67, 16
    s_cmp_lt_u32 s67, 32
    s_cselect_b32 s96, s67, s96
    s_add_u32 s94, s96, s64
    s_and_b32 s94, s94, 63
    s_lshl_b32 s94, s94, 12
    s_add_u32 s94, s94, 65536
    s_lshl_b32 s95, s96, 11
    s_mov_b32 m0, s95
    s_nop 0
    buffer_load_dwordx4 v59, s[48:51], s94 offen sc1 lds
    s_add_u32 m0, s95, 1024
    s_nop 0
    buffer_load_dwordx4 v60, s[48:51], s94 offen sc1 lds
    s_add_u32 s67, s67, 4
    s_sub_u32 s98, s98, 1
    s_cmp_lg_u32 s98, 0
    s_cbranch_scc1 L_kvrest
    s_setprio 1
    s_waitcnt vmcnt(0)
    s_barrier
    s_mov_b32 s99, 1
    s_branch L_clsD
L_clsA:
    s_setprio 2
    s_mov_b32 s99, 0
L_clsD:
    ds_read_b64 v[62:63], v61
    ds_read_b128 v[80:83], v106 offset:0
    ds_read_b128 v[84:87], v106 offset:2048
    s_mov_b64 exec, s[6:7]
    ds_read_b128 v[88:91], v107 offset:0
    ds_read_b128 v[92:95], v107 offset:512
    s_mov_b64 exec, -1
    s_waitcnt lgkmcnt(3)
    v_mfma_f32_32x32x16_bf16 v[24:39], v[80:83], v[4:7], 0
    s_nop 11
    v_exp_f32 v24, v24
    v_exp_f32 v25, v25
    s_mov_b64 exec, s[6:7]
    ds_read_b128 v[96:99], v107 offset:2048
    ds_read_b128 v[100:103], v107 offset:2560
    s_mov_b64 exec, -1
    v_exp_f32 v26, v26
    v_exp_f32 v27, v27
    v_exp_f32 v28, v28
    v_exp_f32 v29, v29
    s_waitcnt lgkmcnt(4)
    v_mfma_f32_32x32x16_bf16 v[40:55], v[84:87], v[4:7], 0
    ds_read_b128 v[80:83], v106 offset:4096
    v_exp_f32 v30, v30
    v_exp_f32 v31, v31
    v_exp_f32 v32, v32
    v_exp_f32 v33, v33
    v_exp_f32 v34, v34
    v_exp_f32 v35, v35
    s_waitcnt lgkmcnt(3)
    v_smfmac_f32_32x32x32_bf16 v[64:79], v[88:91], v[24:31], v56
    v_exp_f32 v36, v36
    v_exp_f32 v37, v37
    v_exp_f32 v38, v38
    v_exp_f32 v39, v39
    v_mul_f32 v12, v12, v62
    v_cmp_lt_f32 vcc, 0x42400000, v12
    v_cmp_u_f32 s[4:5], v12, v12
    s_nop 0
    s_or_b64 vcc, vcc, s[4:5]
    s_cmp_lg_u64 vcc, 0
    s_cselect_b32 s97, 1, 0
    v_readfirstlane_b32 s61, v63
    s_cmp_eq_u32 s90, 1
    s_cbranch_scc0 L_wtB_6
    s_waitcnt vmcnt(0)
    ds_read_b64_tr_b16 v[112:113], v108
    ds_read_b64_tr_b16 v[114:115], v108 offset:1024
    ds_read_b64_tr_b16 v[116:117], v109
    ds_read_b64_tr_b16 v[118:119], v109 offset:1024
    s_waitcnt lgkmcnt(0)
    buffer_store_dwordx4 v[112:115], v2, s[48:51], s88 offen sc1
    s_add_u32 s88, s88, s89
    buffer_store_dwordx4 v[116:119], v2, s[48:51], s88 offen sc1
L_wtB_6:
    v_exp_f32 v40, v40
    v_exp_f32 v41, v41
    v_smfmac_f32_32x32x32_bf16 v[64:79], v[92:95], v[32:39], v56
    s_mov_b64 exec, s[6:7]
    ds_read_b128 v[88:91], v107 offset:4096
    ds_read_b128 v[92:95], v107 offset:4608
    s_mov_b64 exec, -1
    v_exp_f32 v42, v42
    v_exp_f32 v43, v43
    v_exp_f32 v44, v44
    v_exp_f32 v45, v45
    s_waitcnt lgkmcnt(2)
    v_mfma_f32_32x32x16_bf16 v[24:39], v[80:83], v[4:7], 0
    ds_read_b128 v[84:87], v106 offset:6144
    v_exp_f32 v46, v46
    v_exp_f32 v47, v47
    v_exp_f32 v48, v48
    v_exp_f32 v49, v49
    v_exp_f32 v50, v50
    v_exp_f32 v51, v51
    v_smfmac_f32_32x32x32_bf16 v[64:79], v[96:99], v[40:47], v56
    v_exp_f32 v52, v52
    v_exp_f32 v53, v53
    v_exp_f32 v54, v54
    v_exp_f32 v55, v55
    s_or_b32 s92, s2, s56
    s_cmp_lg_u32 s92, 0
    s_cbranch_scc1 L_noepoch
    v_mov_b32 v62, s3
    v_mov_b32 v63, 0
    s_mov_b64 exec, 1
    buffer_store_dword v62, v63, s[48:51], 0 offen
    s_mov_b64 exec, -1
L_noepoch:
    v_exp_f32 v24, v24
    v_exp_f32 v25, v25
    v_smfmac_f32_32x32x32_bf16 v[64:79], v[100:103], v[48:55], v56
    s_mov_b64 exec, s[6:7]
    ds_read_b128 v[96:99], v107 offset:6144
    ds_read_b128 v[100:103], v107 offset:6656
    s_mov_b64 exec, -1
    v_exp_f32 v26, v26
    v_exp_f32 v27, v27
    v_exp_f32 v28, v28
    v_exp_f32 v29, v29
    s_waitcnt lgkmcnt(2)
    v_mfma_f32_32x32x16_bf16 v[40:55], v[84:87], v[4:7], 0
    ds_read_b128 v[80:83], v106 offset:8192
    v_exp_f32 v30, v30
    v_exp_f32 v31, v31
    v_exp_f32 v32, v32
    v_exp_f32 v33, v33
    v_exp_f32 v34, v34
    v_exp_f32 v35, v35
    v_smfmac_f32_32x32x32_bf16 v[64:79], v[88:91], v[24:31], v56
    v_exp_f32 v36, v36
    v_exp_f32 v37, v37
    v_exp_f32 v38, v38
    v_exp_f32 v39, v39
    s_cmp_eq_u32 s90, 1
    s_cbranch_scc0 L_flB_7
    s_waitcnt vmcnt(0)
    s_lshl_b32 s92, s2, 3
    s_add_u32 s92, s92, s56
    s_lshl_b32 s92, s92, 2
    s_add_u32 s92, s92, 40960
    v_mov_b32 v112, s3
    v_mov_b32 v113, 0
    s_mov_b64 exec, 1
    buffer_store_dword v112, v113, s[48:51], s92 offen sc1
    s_mov_b64 exec, -1
L_flB_7:
    v_exp_f32 v40, v40
    v_exp_f32 v41, v41
    v_smfmac_f32_32x32x32_bf16 v[64:79], v[92:95], v[32:39], v56
    s_mov_b64 exec, s[6:7]
    ds_read_b128 v[88:91], v107 offset:8192
    ds_read_b128 v[92:95], v107 offset:8704
    s_mov_b64 exec, -1
    v_exp_f32 v42, v42
    v_exp_f32 v43, v43
    v_exp_f32 v44, v44
    v_exp_f32 v45, v45
    s_waitcnt lgkmcnt(2)
    v_mfma_f32_32x32x16_bf16 v[24:39], v[80:83], v[4:7], 0
    ds_read_b128 v[84:87], v106 offset:10240
    v_exp_f32 v46, v46
    v_exp_f32 v47, v47
    v_exp_f32 v48, v48
    v_exp_f32 v49, v49
    v_exp_f32 v50, v50
    v_exp_f32 v51, v51
    v_smfmac_f32_32x32x32_bf16 v[64:79], v[96:99], v[40:47], v56
    v_exp_f32 v52, v52
    v_exp_f32 v53, v53
    v_exp_f32 v54, v54
    v_exp_f32 v55, v55
    v_exp_f32 v24, v24
    v_exp_f32 v25, v25
    v_smfmac_f32_32x32x32_bf16 v[64:79], v[100:103], v[48:55], v56
    s_mov_b64 exec, s[6:7]
    ds_read_b128 v[96:99], v107 offset:10240
    ds_read_b128 v[100:103], v107 offset:10752
    s_mov_b64 exec, -1
    v_exp_f32 v26, v26
    v_exp_f32 v27, v27
    v_exp_f32 v28, v28
    v_exp_f32 v29, v29
    s_waitcnt lgkmcnt(2)
    v_mfma_f32_32x32x16_bf16 v[40:55], v[84:87], v[4:7], 0
    ds_read_b128 v[80:83], v106 offset:12288
    v_exp_f32 v30, v30
    v_exp_f32 v31, v31
    v_exp_f32 v32, v32
    v_exp_f32 v33, v33
    v_exp_f32 v34, v34
    v_exp_f32 v35, v35
    v_smfmac_f32_32x32x32_bf16 v[64:79], v[88:91], v[24:31], v56
    v_exp_f32 v36, v36
    v_exp_f32 v37, v37
    v_exp_f32 v38, v38
    v_exp_f32 v39, v39
    v_exp_f32 v40, v40
    v_exp_f32 v41, v41
    v_smfmac_f32_32x32x32_bf16 v[64:79], v[92:95], v[32:39], v56
    s_mov_b64 exec, s[6:7]
    ds_read_b128 v[88:91], v107 offset:12288
    ds_read_b128 v[92:95], v107 offset:12800
    s_mov_b64 exec, -1
    v_exp_f32 v42, v42
    v_exp_f32 v43, v43
    v_exp_f32 v44, v44
    v_exp_f32 v45, v45
    s_waitcnt lgkmcnt(2)
    v_mfma_f32_32x32x16_bf16 v[24:39], v[80:83], v[4:7], 0
    ds_read_b128 v[84:87], v106 offset:14336
    v_exp_f32 v46, v46
    v_exp_f32 v47, v47
    v_exp_f32 v48, v48
    v_exp_f32 v49, v49
    v_exp_f32 v50, v50
    v_exp_f32 v51, v51
    v_smfmac_f32_32x32x32_bf16 v[64:79], v[96:99], v[40:47], v56
    v_exp_f32 v52, v52
    v_exp_f32 v53, v53
    v_exp_f32 v54, v54
    v_exp_f32 v55, v55
    v_exp_f32 v24, v24
    v_exp_f32 v25, v25
    v_smfmac_f32_32x32x32_bf16 v[64:79], v[100:103], v[48:55], v56
    s_mov_b64 exec, s[6:7]
    ds_read_b128 v[96:99], v107 offset:14336
    ds_read_b128 v[100:103], v107 offset:14848
    s_mov_b64 exec, -1
    v_exp_f32 v26, v26
    v_exp_f32 v27, v27
    v_exp_f32 v28, v28
    v_exp_f32 v29, v29
    s_waitcnt lgkmcnt(2)
    v_mfma_f32_32x32x16_bf16 v[40:55], v[84:87], v[4:7], 0
    ds_read_b128 v[80:83], v106 offset:16384
    v_exp_f32 v30, v30
    v_exp_f32 v31, v31
    v_exp_f32 v32, v32
    v_exp_f32 v33, v33
    v_exp_f32 v34, v34
    v_exp_f32 v35, v35
    v_smfmac_f32_32x32x32_bf16 v[64:79], v[88:91], v[24:31], v56
    v_exp_f32 v36, v36
    v_exp_f32 v37, v37
    v_exp_f32 v38, v38
    v_exp_f32 v39, v39
    v_exp_f32 v40, v40
    v_exp_f32 v41, v41
    v_smfmac_f32_32x32x32_bf16 v[64:79], v[92:95], v[32:39], v56
    s_mov_b64 exec, s[6:7]
    ds_read_b128 v[88:91], v107 offset:16384
    ds_read_b128 v[92:95], v107 offset:16896
    s_mov_b64 exec, -1
    v_exp_f32 v42, v42
    v_exp_f32 v43, v43
    v_exp_f32 v44, v44
    v_exp_f32 v45, v45
    s_waitcnt lgkmcnt(2)
    v_mfma_f32_32x32x16_bf16 v[24:39], v[80:83], v[4:7], 0
    ds_read_b128 v[84:87], v106 offset:18432
    v_exp_f32 v46, v46
    v_exp_f32 v47, v47
    v_exp_f32 v48, v48
    v_exp_f32 v49, v49
    v_exp_f32 v50, v50
    v_exp_f32 v51, v51
    v_smfmac_f32_32x32x32_bf16 v[64:79], v[96:99], v[40:47], v56
    v_exp_f32 v52, v52
    v_exp_f32 v53, v53
    v_exp_f32 v54, v54
    v_exp_f32 v55, v55
    v_exp_f32 v24, v24
    v_exp_f32 v25, v25
    v_smfmac_f32_32x32x32_bf16 v[64:79], v[100:103], v[48:55], v56
    s_mov_b64 exec, s[6:7]
    ds_read_b128 v[96:99], v107 offset:18432
    ds_read_b128 v[100:103], v107 offset:18944
    s_mov_b64 exec, -1
    v_exp_f32 v26, v26
    v_exp_f32 v27, v27
    v_exp_f32 v28, v28
    v_exp_f32 v29, v29
    s_waitcnt lgkmcnt(2)
    v_mfma_f32_32x32x16_bf16 v[40:55], v[84:87], v[4:7], 0
    ds_read_b128 v[80:83], v106 offset:20480
    v_exp_f32 v30, v30
    v_exp_f32 v31, v31
    v_exp_f32 v32, v32
    v_exp_f32 v33, v33
    v_exp_f32 v34, v34
    v_exp_f32 v35, v35
    v_smfmac_f32_32x32x32_bf16 v[64:79], v[88:91], v[24:31], v56
    v_exp_f32 v36, v36
    v_exp_f32 v37, v37
    v_exp_f32 v38, v38
    v_exp_f32 v39, v39
    v_exp_f32 v40, v40
    v_exp_f32 v41, v41
    v_smfmac_f32_32x32x32_bf16 v[64:79], v[92:95], v[32:39], v56
    s_mov_b64 exec, s[6:7]
    ds_read_b128 v[88:91], v107 offset:20480
    ds_read_b128 v[92:95], v107 offset:20992
    s_mov_b64 exec, -1
    v_exp_f32 v42, v42
    v_exp_f32 v43, v43
    v_exp_f32 v44, v44
    v_exp_f32 v45, v45
    s_waitcnt lgkmcnt(2)
    v_mfma_f32_32x32x16_bf16 v[24:39], v[80:83], v[4:7], 0
    ds_read_b128 v[84:87], v106 offset:22528
    v_exp_f32 v46, v46
    v_exp_f32 v47, v47
    v_exp_f32 v48, v48
    v_exp_f32 v49, v49
    v_exp_f32 v50, v50
    v_exp_f32 v51, v51
    v_smfmac_f32_32x32x32_bf16 v[64:79], v[96:99], v[40:47], v56
    v_exp_f32 v52, v52
    v_exp_f32 v53, v53
    v_exp_f32 v54, v54
    v_exp_f32 v55, v55
    v_exp_f32 v24, v24
    v_exp_f32 v25, v25
    v_smfmac_f32_32x32x32_bf16 v[64:79], v[100:103], v[48:55], v56
    s_mov_b64 exec, s[6:7]
    ds_read_b128 v[96:99], v107 offset:22528
    ds_read_b128 v[100:103], v107 offset:23040
    s_mov_b64 exec, -1
    v_exp_f32 v26, v26
    v_exp_f32 v27, v27
    v_exp_f32 v28, v28
    v_exp_f32 v29, v29
    s_waitcnt lgkmcnt(2)
    v_mfma_f32_32x32x16_bf16 v[40:55], v[84:87], v[4:7], 0
    ds_read_b128 v[80:83], v106 offset:24576
    v_exp_f32 v30, v30
    v_exp_f32 v31, v31
    v_exp_f32 v32, v32
    v_exp_f32 v33, v33
    v_exp_f32 v34, v34
    v_exp_f32 v35, v35
    v_smfmac_f32_32x32x32_bf16 v[64:79], v[88:91], v[24:31], v56
    v_exp_f32 v36, v36
    v_exp_f32 v37, v37
    v_exp_f32 v38, v38
    v_exp_f32 v39, v39
    s_cmp_eq_u32 s90, 0
    s_cbranch_scc0 L_wtA_8
    s_waitcnt vmcnt(0)
    ds_read_b64_tr_b16 v[112:113], v108
    ds_read_b64_tr_b16 v[114:115], v108 offset:1024
    ds_read_b64_tr_b16 v[116:117], v109
    ds_read_b64_tr_b16 v[118:119], v109 offset:1024
    s_waitcnt lgkmcnt(0)
    buffer_store_dwordx4 v[112:115], v2, s[48:51], s88 offen sc1
    s_add_u32 s88, s88, s89
    buffer_store_dwordx4 v[116:119], v2, s[48:51], s88 offen sc1
L_wtA_8:
    v_exp_f32 v40, v40
    v_exp_f32 v41, v41
    v_smfmac_f32_32x32x32_bf16 v[64:79], v[92:95], v[32:39], v56
    s_mov_b64 exec, s[6:7]
    ds_read_b128 v[88:91], v107 offset:24576
    ds_read_b128 v[92:95], v107 offset:25088
    s_mov_b64 exec, -1
    v_exp_f32 v42, v42
    v_exp_f32 v43, v43
    v_exp_f32 v44, v44
    v_exp_f32 v45, v45
    s_waitcnt lgkmcnt(2)
    v_mfma_f32_32x32x16_bf16 v[24:39], v[80:83], v[4:7], 0
    ds_read_b128 v[84:87], v106 offset:26624
    v_exp_f32 v46, v46
    v_exp_f32 v47, v47
    v_exp_f32 v48, v48
    v_exp_f32 v49, v49
    v_exp_f32 v50, v50
    v_exp_f32 v51, v51
    v_smfmac_f32_32x32x32_bf16 v[64:79], v[96:99], v[40:47], v56
    v_exp_f32 v52, v52
    v_exp_f32 v53, v53
    v_exp_f32 v54, v54
    v_exp_f32 v55, v55
    v_exp_f32 v24, v24
    v_exp_f32 v25, v25
    v_smfmac_f32_32x32x32_bf16 v[64:79], v[100:103], v[48:55], v56
    s_mov_b64 exec, s[6:7]
    ds_read_b128 v[96:99], v107 offset:26624
    ds_read_b128 v[100:103], v107 offset:27136
    s_mov_b64 exec, -1
    v_exp_f32 v26, v26
    v_exp_f32 v27, v27
    v_exp_f32 v28, v28
    v_exp_f32 v29, v29
    s_waitcnt lgkmcnt(2)
    v_mfma_f32_32x32x16_bf16 v[40:55], v[84:87], v[4:7], 0
    ds_read_b128 v[80:83], v106 offset:28672
    v_exp_f32 v30, v30
    v_exp_f32 v31, v31
    v_exp_f32 v32, v32
    v_exp_f32 v33, v33
    v_exp_f32 v34, v34
    v_exp_f32 v35, v35
    v_smfmac_f32_32x32x32_bf16 v[64:79], v[88:91], v[24:31], v56
    v_exp_f32 v36, v36
    v_exp_f32 v37, v37
    v_exp_f32 v38, v38
    v_exp_f32 v39, v39
    v_exp_f32 v40, v40
    v_exp_f32 v41, v41
    v_smfmac_f32_32x32x32_bf16 v[64:79], v[92:95], v[32:39], v56
    s_mov_b64 exec, s[6:7]
    ds_read_b128 v[88:91], v107 offset:28672
    ds_read_b128 v[92:95], v107 offset:29184
    s_mov_b64 exec, -1
    v_exp_f32 v42, v42
    v_exp_f32 v43, v43
    v_exp_f32 v44, v44
    v_exp_f32 v45, v45
    s_waitcnt lgkmcnt(2)
    v_mfma_f32_32x32x16_bf16 v[24:39], v[80:83], v[4:7], 0
    ds_read_b128 v[84:87], v106 offset:30720
    v_exp_f32 v46, v46
    v_exp_f32 v47, v47
    v_exp_f32 v48, v48
    v_exp_f32 v49, v49
    v_exp_f32 v50, v50
    v_exp_f32 v51, v51
    v_smfmac_f32_32x32x32_bf16 v[64:79], v[96:99], v[40:47], v56
    v_exp_f32 v52, v52
    v_exp_f32 v53, v53
    v_exp_f32 v54, v54
    v_exp_f32 v55, v55
    s_cmp_eq_u32 s99, 1
    s_cbranch_scc1 L_b5_9
    s_barrier
L_b5_9:
    v_exp_f32 v24, v24
    v_exp_f32 v25, v25
    v_smfmac_f32_32x32x32_bf16 v[64:79], v[100:103], v[48:55], v56
    s_mov_b64 exec, s[6:7]
    ds_read_b128 v[96:99], v107 offset:30720
    ds_read_b128 v[100:103], v107 offset:31232
    s_mov_b64 exec, -1
    v_exp_f32 v26, v26
    v_exp_f32 v27, v27
    v_exp_f32 v28, v28
    v_exp_f32 v29, v29
    s_waitcnt lgkmcnt(2)
    v_mfma_f32_32x32x16_bf16 v[40:55], v[84:87], v[4:7], 0
    ds_read_b128 v[80:83], v104 offset:0
    v_exp_f32 v30, v30
    v_exp_f32 v31, v31
    v_exp_f32 v32, v32
    v_exp_f32 v33, v33
    v_exp_f32 v34, v34
    v_exp_f32 v35, v35
    v_smfmac_f32_32x32x32_bf16 v[64:79], v[88:91], v[24:31], v56
    v_exp_f32 v36, v36
    v_exp_f32 v37, v37
    v_exp_f32 v38, v38
    v_exp_f32 v39, v39
    v_exp_f32 v40, v40
    v_exp_f32 v41, v41
    v_smfmac_f32_32x32x32_bf16 v[64:79], v[92:95], v[32:39], v56
    s_mov_b64 exec, s[6:7]
    ds_read_b128 v[88:91], v105 offset:0
    ds_read_b128 v[92:95], v105 offset:512
    s_mov_b64 exec, -1
    v_exp_f32 v42, v42
    v_exp_f32 v43, v43
    v_exp_f32 v44, v44
    v_exp_f32 v45, v45
    s_waitcnt lgkmcnt(2)
    v_mfma_f32_32x32x16_bf16 v[24:39], v[80:83], v[4:7], 0
    ds_read_b128 v[84:87], v104 offset:2048
    v_exp_f32 v46, v46
    v_exp_f32 v47, v47
    v_exp_f32 v48, v48
    v_exp_f32 v49, v49
    v_exp_f32 v50, v50
    v_exp_f32 v51, v51
    v_smfmac_f32_32x32x32_bf16 v[64:79], v[96:99], v[40:47], v56
    v_exp_f32 v52, v52
    v_exp_f32 v53, v53
    v_exp_f32 v54, v54
    v_exp_f32 v55, v55
    v_exp_f32 v24, v24
    v_exp_f32 v25, v25
    v_smfmac_f32_32x32x32_bf16 v[64:79], v[100:103], v[48:55], v56
    s_mov_b64 exec, s[6:7]
    ds_read_b128 v[96:99], v105 offset:2048
    ds_read_b128 v[100:103], v105 offset:2560
    s_mov_b64 exec, -1
    v_exp_f32 v26, v26
    v_exp_f32 v27, v27
    v_exp_f32 v28, v28
    v_exp_f32 v29, v29
    s_waitcnt lgkmcnt(2)
    v_mfma_f32_32x32x16_bf16 v[40:55], v[84:87], v[4:7], 0
    ds_read_b128 v[80:83], v104 offset:4096
    v_exp_f32 v30, v30
    v_exp_f32 v31, v31
    v_exp_f32 v32, v32
    v_exp_f32 v33, v33
    v_exp_f32 v34, v34
    v_exp_f32 v35, v35
    v_smfmac_f32_32x32x32_bf16 v[64:79], v[88:91], v[24:31], v56
    v_exp_f32 v36, v36
    v_exp_f32 v37, v37
    v_exp_f32 v38, v38
    v_exp_f32 v39, v39
    v_exp_f32 v40, v40
    v_exp_f32 v41, v41
    v_smfmac_f32_32x32x32_bf16 v[64:79], v[92:95], v[32:39], v56
    s_mov_b64 exec, s[6:7]
    ds_read_b128 v[88:91], v105 offset:4096
    ds_read_b128 v[92:95], v105 offset:4608
    s_mov_b64 exec, -1
    v_exp_f32 v42, v42
    v_exp_f32 v43, v43
    v_exp_f32 v44, v44
    v_exp_f32 v45, v45
    s_waitcnt lgkmcnt(2)
    v_mfma_f32_32x32x16_bf16 v[24:39], v[80:83], v[4:7], 0
    ds_read_b128 v[84:87], v104 offset:6144
    v_exp_f32 v46, v46
    v_exp_f32 v47, v47
    v_exp_f32 v48, v48
    v_exp_f32 v49, v49
    v_exp_f32 v50, v50
    v_exp_f32 v51, v51
    v_smfmac_f32_32x32x32_bf16 v[64:79], v[96:99], v[40:47], v56
    v_exp_f32 v52, v52
    v_exp_f32 v53, v53
    v_exp_f32 v54, v54
    v_exp_f32 v55, v55
    s_cmp_eq_u32 s90, 0
    s_cbranch_scc0 L_flA_10
    s_waitcnt vmcnt(0)
    s_lshl_b32 s92, s2, 3
    s_add_u32 s92, s92, s56
    s_lshl_b32 s92, s92, 2
    s_add_u32 s92, s92, 40960
    v_mov_b32 v112, s3
    v_mov_b32 v113, 0
    s_mov_b64 exec, 1
    buffer_store_dword v112, v113, s[48:51], s92 offen sc1
    s_mov_b64 exec, -1
L_flA_10:
    v_exp_f32 v24, v24
    v_exp_f32 v25, v25
    v_smfmac_f32_32x32x32_bf16 v[64:79], v[100:103], v[48:55], v56
    s_mov_b64 exec, s[6:7]
    ds_read_b128 v[96:99], v105 offset:6144
    ds_read_b128 v[100:103], v105 offset:6656
    s_mov_b64 exec, -1
    v_exp_f32 v26, v26
    v_exp_f32 v27, v27
    v_exp_f32 v28, v28
    v_exp_f32 v29, v29
    s_waitcnt lgkmcnt(2)
    v_mfma_f32_32x32x16_bf16 v[40:55], v[84:87], v[4:7], 0
    ds_read_b128 v[80:83], v104 offset:8192
    v_exp_f32 v30, v30
    v_exp_f32 v31, v31
    v_exp_f32 v32, v32
    v_exp_f32 v33, v33
    v_exp_f32 v34, v34
    v_exp_f32 v35, v35
    v_smfmac_f32_32x32x32_bf16 v[64:79], v[88:91], v[24:31], v56
    v_exp_f32 v36, v36
    v_exp_f32 v37, v37
    v_exp_f32 v38, v38
    v_exp_f32 v39, v39
    v_exp_f32 v40, v40
    v_exp_f32 v41, v41
    v_smfmac_f32_32x32x32_bf16 v[64:79], v[92:95], v[32:39], v56
    s_mov_b64 exec, s[6:7]
    ds_read_b128 v[88:91], v105 offset:8192
    ds_read_b128 v[92:95], v105 offset:8704
    s_mov_b64 exec, -1
    v_exp_f32 v42, v42
    v_exp_f32 v43, v43
    v_exp_f32 v44, v44
    v_exp_f32 v45, v45
    s_waitcnt lgkmcnt(2)
    v_mfma_f32_32x32x16_bf16 v[24:39], v[80:83], v[4:7], 0
    ds_read_b128 v[84:87], v104 offset:10240
    v_exp_f32 v46, v46
    v_exp_f32 v47, v47
    v_exp_f32 v48, v48
    v_exp_f32 v49, v49
    v_exp_f32 v50, v50
    v_exp_f32 v51, v51
    v_smfmac_f32_32x32x32_bf16 v[64:79], v[96:99], v[40:47], v56
    v_exp_f32 v52, v52
    v_exp_f32 v53, v53
    v_exp_f32 v54, v54
    v_exp_f32 v55, v55
    v_exp_f32 v24, v24
    v_exp_f32 v25, v25
    v_smfmac_f32_32x32x32_bf16 v[64:79], v[100:103], v[48:55], v56
    s_mov_b64 exec, s[6:7]
    ds_read_b128 v[96:99], v105 offset:10240
    ds_read_b128 v[100:103], v105 offset:10752
    s_mov_b64 exec, -1
    v_exp_f32 v26, v26
    v_exp_f32 v27, v27
    v_exp_f32 v28, v28
    v_exp_f32 v29, v29
    s_waitcnt lgkmcnt(2)
    v_mfma_f32_32x32x16_bf16 v[40:55], v[84:87], v[4:7], 0
    ds_read_b128 v[80:83], v104 offset:12288
    v_exp_f32 v30, v30
    v_exp_f32 v31, v31
    v_exp_f32 v32, v32
    v_exp_f32 v33, v33
    v_exp_f32 v34, v34
    v_exp_f32 v35, v35
    v_smfmac_f32_32x32x32_bf16 v[64:79], v[88:91], v[24:31], v56
    v_exp_f32 v36, v36
    v_exp_f32 v37, v37
    v_exp_f32 v38, v38
    v_exp_f32 v39, v39
    v_exp_f32 v40, v40
    v_exp_f32 v41, v41
    v_smfmac_f32_32x32x32_bf16 v[64:79], v[92:95], v[32:39], v56
    s_mov_b64 exec, s[6:7]
    ds_read_b128 v[88:91], v105 offset:12288
    ds_read_b128 v[92:95], v105 offset:12800
    s_mov_b64 exec, -1
    v_exp_f32 v42, v42
    v_exp_f32 v43, v43
    v_exp_f32 v44, v44
    v_exp_f32 v45, v45
    s_waitcnt lgkmcnt(2)
    v_mfma_f32_32x32x16_bf16 v[24:39], v[80:83], v[4:7], 0
    ds_read_b128 v[84:87], v104 offset:14336
    v_exp_f32 v46, v46
    v_exp_f32 v47, v47
    v_exp_f32 v48, v48
    v_exp_f32 v49, v49
    v_exp_f32 v50, v50
    v_exp_f32 v51, v51
    v_smfmac_f32_32x32x32_bf16 v[64:79], v[96:99], v[40:47], v56
    v_exp_f32 v52, v52
    v_exp_f32 v53, v53
    v_exp_f32 v54, v54
    v_exp_f32 v55, v55
    v_exp_f32 v24, v24
    v_exp_f32 v25, v25
    v_smfmac_f32_32x32x32_bf16 v[64:79], v[100:103], v[48:55], v56
    s_mov_b64 exec, s[6:7]
    ds_read_b128 v[96:99], v105 offset:14336
    ds_read_b128 v[100:103], v105 offset:14848
    s_mov_b64 exec, -1
    v_exp_f32 v26, v26
    v_exp_f32 v27, v27
    v_exp_f32 v28, v28
    v_exp_f32 v29, v29
    s_waitcnt lgkmcnt(2)
    v_mfma_f32_32x32x16_bf16 v[40:55], v[84:87], v[4:7], 0
    ds_read_b128 v[80:83], v104 offset:16384
    v_exp_f32 v30, v30
    v_exp_f32 v31, v31
    v_exp_f32 v32, v32
    v_exp_f32 v33, v33
    v_exp_f32 v34, v34
    v_exp_f32 v35, v35
    v_smfmac_f32_32x32x32_bf16 v[64:79], v[88:91], v[24:31], v56
    v_exp_f32 v36, v36
    v_exp_f32 v37, v37
    v_exp_f32 v38, v38
    v_exp_f32 v39, v39
    v_exp_f32 v40, v40
    v_exp_f32 v41, v41
    v_smfmac_f32_32x32x32_bf16 v[64:79], v[92:95], v[32:39], v56
    s_mov_b64 exec, s[6:7]
    ds_read_b128 v[88:91], v105 offset:16384
    ds_read_b128 v[92:95], v105 offset:16896
    s_mov_b64 exec, -1
    v_exp_f32 v42, v42
    v_exp_f32 v43, v43
    v_exp_f32 v44, v44
    v_exp_f32 v45, v45
    s_waitcnt lgkmcnt(2)
    v_mfma_f32_32x32x16_bf16 v[24:39], v[80:83], v[4:7], 0
    ds_read_b128 v[84:87], v104 offset:18432
    v_exp_f32 v46, v46
    v_exp_f32 v47, v47
    v_exp_f32 v48, v48
    v_exp_f32 v49, v49
    v_exp_f32 v50, v50
    v_exp_f32 v51, v51
    v_smfmac_f32_32x32x32_bf16 v[64:79], v[96:99], v[40:47], v56
    v_exp_f32 v52, v52
    v_exp_f32 v53, v53
    v_exp_f32 v54, v54
    v_exp_f32 v55, v55
    v_exp_f32 v24, v24
    v_exp_f32 v25, v25
    v_smfmac_f32_32x32x32_bf16 v[64:79], v[100:103], v[48:55], v56
    s_mov_b64 exec, s[6:7]
    ds_read_b128 v[96:99], v105 offset:18432
    ds_read_b128 v[100:103], v105 offset:18944
    s_mov_b64 exec, -1
    v_exp_f32 v26, v26
    v_exp_f32 v27, v27
    v_exp_f32 v28, v28
    v_exp_f32 v29, v29
    s_waitcnt lgkmcnt(2)
    v_mfma_f32_32x32x16_bf16 v[40:55], v[84:87], v[4:7], 0
    ds_read_b128 v[80:83], v104 offset:20480
    v_exp_f32 v30, v30
    v_exp_f32 v31, v31
    v_exp_f32 v32, v32
    v_exp_f32 v33, v33
    v_exp_f32 v34, v34
    v_exp_f32 v35, v35
    v_smfmac_f32_32x32x32_bf16 v[64:79], v[88:91], v[24:31], v56
    v_exp_f32 v36, v36
    v_exp_f32 v37, v37
    v_exp_f32 v38, v38
    v_exp_f32 v39, v39
    v_exp_f32 v40, v40
    v_exp_f32 v41, v41
    v_smfmac_f32_32x32x32_bf16 v[64:79], v[92:95], v[32:39], v56
    s_mov_b64 exec, s[6:7]
    ds_read_b128 v[88:91], v105 offset:20480
    ds_read_b128 v[92:95], v105 offset:20992
    s_mov_b64 exec, -1
    v_exp_f32 v42, v42
    v_exp_f32 v43, v43
    v_exp_f32 v44, v44
    v_exp_f32 v45, v45
    s_waitcnt lgkmcnt(2)
    v_mfma_f32_32x32x16_bf16 v[24:39], v[80:83], v[4:7], 0
    ds_read_b128 v[84:87], v104 offset:22528
    v_exp_f32 v46, v46
    v_exp_f32 v47, v47
    v_exp_f32 v48, v48
    v_exp_f32 v49, v49
    v_exp_f32 v50, v50
    v_exp_f32 v51, v51
    v_smfmac_f32_32x32x32_bf16 v[64:79], v[96:99], v[40:47], v56
    v_exp_f32 v52, v52
    v_exp_f32 v53, v53
    v_exp_f32 v54, v54
    v_exp_f32 v55, v55
    v_exp_f32 v24, v24
    v_exp_f32 v25, v25
    v_smfmac_f32_32x32x32_bf16 v[64:79], v[100:103], v[48:55], v56
    s_mov_b64 exec, s[6:7]
    ds_read_b128 v[96:99], v105 offset:22528
    ds_read_b128 v[100:103], v105 offset:23040
    s_mov_b64 exec, -1
    v_exp_f32 v26, v26
    v_exp_f32 v27, v27
    v_exp_f32 v28, v28
    v_exp_f32 v29, v29
    s_waitcnt lgkmcnt(2)
    v_mfma_f32_32x32x16_bf16 v[40:55], v[84:87], v[4:7], 0
    ds_read_b128 v[80:83], v104 offset:24576
    v_exp_f32 v30, v30
    v_exp_f32 v31, v31
    v_exp_f32 v32, v32
    v_exp_f32 v33, v33
    v_exp_f32 v34, v34
    v_exp_f32 v35, v35
    v_smfmac_f32_32x32x32_bf16 v[64:79], v[88:91], v[24:31], v56
    v_exp_f32 v36, v36
    v_exp_f32 v37, v37
    v_exp_f32 v38, v38
    v_exp_f32 v39, v39
    v_exp_f32 v40, v40
    v_exp_f32 v41, v41
    v_smfmac_f32_32x32x32_bf16 v[64:79], v[92:95], v[32:39], v56
    s_mov_b64 exec, s[6:7]
    ds_read_b128 v[88:91], v105 offset:24576
    ds_read_b128 v[92:95], v105 offset:25088
    s_mov_b64 exec, -1
    v_exp_f32 v42, v42
    v_exp_f32 v43, v43
    v_exp_f32 v44, v44
    v_exp_f32 v45, v45
    s_waitcnt lgkmcnt(2)
    v_mfma_f32_32x32x16_bf16 v[24:39], v[80:83], v[4:7], 0
    ds_read_b128 v[84:87], v104 offset:26624
    v_exp_f32 v46, v46
    v_exp_f32 v47, v47
    v_exp_f32 v48, v48
    v_exp_f32 v49, v49
    v_exp_f32 v50, v50
    v_exp_f32 v51, v51
    v_smfmac_f32_32x32x32_bf16 v[64:79], v[96:99], v[40:47], v56
    v_exp_f32 v52, v52
    v_exp_f32 v53, v53
    v_exp_f32 v54, v54
    v_exp_f32 v55, v55
    v_exp_f32 v24, v24
    v_exp_f32 v25, v25
    v_smfmac_f32_32x32x32_bf16 v[64:79], v[100:103], v[48:55], v56
    s_mov_b64 exec, s[6:7]
    ds_read_b128 v[96:99], v105 offset:26624
    ds_read_b128 v[100:103], v105 offset:27136
    s_mov_b64 exec, -1
    v_exp_f32 v26, v26
    v_exp_f32 v27, v27
    v_exp_f32 v28, v28
    v_exp_f32 v29, v29
    s_waitcnt lgkmcnt(2)
    v_mfma_f32_32x32x16_bf16 v[40:55], v[84:87], v[4:7], 0
    ds_read_b128 v[80:83], v104 offset:28672
    v_exp_f32 v30, v30
    v_exp_f32 v31, v31
    v_exp_f32 v32, v32
    v_exp_f32 v33, v33
    v_exp_f32 v34, v34
    v_exp_f32 v35, v35
    v_smfmac_f32_32x32x32_bf16 v[64:79], v[88:91], v[24:31], v56
    v_exp_f32 v36, v36
    v_exp_f32 v37, v37
    v_exp_f32 v38, v38
    v_exp_f32 v39, v39
    v_exp_f32 v40, v40
    v_exp_f32 v41, v41
    v_smfmac_f32_32x32x32_bf16 v[64:79], v[92:95], v[32:39], v56
    s_mov_b64 exec, s[6:7]
    ds_read_b128 v[88:91], v105 offset:28672
    ds_read_b128 v[92:95], v105 offset:29184
    s_mov_b64 exec, -1
    v_exp_f32 v42, v42
    v_exp_f32 v43, v43
    v_exp_f32 v44, v44
    v_exp_f32 v45, v45
    s_waitcnt lgkmcnt(2)
    v_mfma_f32_32x32x16_bf16 v[24:39], v[80:83], v[4:7], 0
    ds_read_b128 v[84:87], v104 offset:30720
    v_exp_f32 v46, v46
    v_exp_f32 v47, v47
    v_exp_f32 v48, v48
    v_exp_f32 v49, v49
    v_exp_f32 v50, v50
    v_exp_f32 v51, v51
    v_smfmac_f32_32x32x32_bf16 v[64:79], v[96:99], v[40:47], v56
    v_exp_f32 v52, v52
    v_exp_f32 v53, v53
    v_exp_f32 v54, v54
    v_exp_f32 v55, v55
    v_exp_f32 v24, v24
    v_exp_f32 v25, v25
    v_smfmac_f32_32x32x32_bf16 v[64:79], v[100:103], v[48:55], v56
    s_mov_b64 exec, s[6:7]
    ds_read_b128 v[96:99], v105 offset:30720
    ds_read_b128 v[100:103], v105 offset:31232
    s_mov_b64 exec, -1
    v_exp_f32 v26, v26
    v_exp_f32 v27, v27
    v_exp_f32 v28, v28
    v_exp_f32 v29, v29
    s_waitcnt lgkmcnt(2)
    v_mfma_f32_32x32x16_bf16 v[40:55], v[84:87], v[4:7], 0
    ds_read_b128 v[80:83], v104 offset:32768
    v_exp_f32 v30, v30
    v_exp_f32 v31, v31
    v_exp_f32 v32, v32
    v_exp_f32 v33, v33
    v_exp_f32 v34, v34
    v_exp_f32 v35, v35
    v_smfmac_f32_32x32x32_bf16 v[64:79], v[88:91], v[24:31], v56
    v_exp_f32 v36, v36
    v_exp_f32 v37, v37
    v_exp_f32 v38, v38
    v_exp_f32 v39, v39
    buffer_load_dword v110, v57, s[48:51], 0 offen sc1
    buffer_load_dword v111, v58, s[48:51], 0 offen sc1
    v_exp_f32 v40, v40
    v_exp_f32 v41, v41
    v_smfmac_f32_32x32x32_bf16 v[64:79], v[92:95], v[32:39], v56
    s_mov_b64 exec, s[6:7]
    ds_read_b128 v[88:91], v105 offset:32768
    ds_read_b128 v[92:95], v105 offset:33280
    s_mov_b64 exec, -1
    v_exp_f32 v42, v42
    v_exp_f32 v43, v43
    v_exp_f32 v44, v44
    v_exp_f32 v45, v45
    s_waitcnt lgkmcnt(2)
    v_mfma_f32_32x32x16_bf16 v[24:39], v[80:83], v[4:7], 0
    ds_read_b128 v[84:87], v104 offset:34816
    v_exp_f32 v46, v46
    v_exp_f32 v47, v47
    v_exp_f32 v48, v48
    v_exp_f32 v49, v49
    v_exp_f32 v50, v50
    v_exp_f32 v51, v51
    v_smfmac_f32_32x32x32_bf16 v[64:79], v[96:99], v[40:47], v56
    v_exp_f32 v52, v52
    v_exp_f32 v53, v53
    v_exp_f32 v54, v54
    v_exp_f32 v55, v55
    s_waitcnt vmcnt(0)
    s_mov_b32 s98, 200000
L_wtchk:
    v_xor_b32 v110, s3, v110
    v_xor_b32 v111, s3, v111
    v_or_b32 v110, v110, v111
    v_cmp_ne_u32 vcc, 0, v110
    s_nop 0
    s_cbranch_vccz L_wtok
    s_sub_u32 s98, s98, 1
    s_cmp_eq_u32 s98, 0
    s_cbranch_scc1 L_wtok
    s_sleep 2
    buffer_load_dword v110, v57, s[48:51], 0 offen sc1
    buffer_load_dword v111, v58, s[48:51], 0 offen sc1
    s_waitcnt vmcnt(0)
    s_branch L_wtchk
L_wtok:
    s_lshl_b32 s92, s57, 1
    s_add_u32 s92, s92, s62
    s_lshl_b32 s92, s92, 5
    s_lshl_b32 s93, s90, 4
    s_add_u32 s92, s92, s93
    s_lshl_b32 s92, s92, 10
    s_add_u32 s66, s92, 12582912
    s_lshl_b32 s93, s90, 8
    v_xor_b32 v57, s93, v2
    v_exp_f32 v24, v24
    v_exp_f32 v25, v25
    v_smfmac_f32_32x32x32_bf16 v[64:79], v[100:103], v[48:55], v56
    s_mov_b64 exec, s[6:7]
    ds_read_b128 v[96:99], v105 offset:34816
    ds_read_b128 v[100:103], v105 offset:35328
    s_mov_b64 exec, -1
    v_exp_f32 v26, v26
    v_exp_f32 v27, v27
    v_exp_f32 v28, v28
    v_exp_f32 v29, v29
    s_waitcnt lgkmcnt(2)
    v_mfma_f32_32x32x16_bf16 v[40:55], v[84:87], v[4:7], 0
    ds_read_b128 v[80:83], v104 offset:36864
    buffer_load_dwordx4 v[152:155], v2, s[48:51], s65 offen offset:0 sc1
    v_exp_f32 v30, v30
    v_exp_f32 v31, v31
    v_exp_f32 v32, v32
    v_exp_f32 v33, v33
    v_exp_f32 v34, v34
    v_exp_f32 v35, v35
    v_smfmac_f32_32x32x32_bf16 v[64:79], v[88:91], v[24:31], v56
    buffer_load_dwordx4 v[156:159], v2, s[48:51], s65 offen offset:1024 sc1
    v_exp_f32 v36, v36
    v_exp_f32 v37, v37
    v_exp_f32 v38, v38
    v_exp_f32 v39, v39
    v_exp_f32 v40, v40
    v_exp_f32 v41, v41
    v_smfmac_f32_32x32x32_bf16 v[64:79], v[92:95], v[32:39], v56
    s_mov_b64 exec, s[6:7]
    ds_read_b128 v[88:91], v105 offset:36864
    ds_read_b128 v[92:95], v105 offset:37376
    s_mov_b64 exec, -1
    v_exp_f32 v42, v42
    v_exp_f32 v43, v43
    v_exp_f32 v44, v44
    v_exp_f32 v45, v45
    s_waitcnt lgkmcnt(2)
    v_mfma_f32_32x32x16_bf16 v[24:39], v[80:83], v[4:7], 0
    ds_read_b128 v[84:87], v104 offset:38912
    buffer_load_dwordx4 v[160:163], v2, s[48:51], s65 offen offset:2048 sc1
    v_exp_f32 v46, v46
    v_exp_f32 v47, v47
    v_exp_f32 v48, v48
    v_exp_f32 v49, v49
    v_exp_f32 v50, v50
    v_exp_f32 v51, v51
    v_smfmac_f32_32x32x32_bf16 v[64:79], v[96:99], v[40:47], v56
    buffer_load_dwordx4 v[164:167], v2, s[48:51], s65 offen offset:3072 sc1
    s_add_u32 s65, s65, 4096
    v_exp_f32 v52, v52
    v_exp_f32 v53, v53
    v_exp_f32 v54, v54
    v_exp_f32 v55, v55
    v_exp_f32 v24, v24
    v_exp_f32 v25, v25
    v_smfmac_f32_32x32x32_bf16 v[64:79], v[100:103], v[48:55], v56
    s_mov_b64 exec, s[6:7]
    ds_read_b128 v[96:99], v105 offset:38912
    ds_read_b128 v[100:103], v105 offset:39424
    s_mov_b64 exec, -1
    v_exp_f32 v26, v26
    v_exp_f32 v27, v27
    v_exp_f32 v28, v28
    v_exp_f32 v29, v29
    s_waitcnt lgkmcnt(2)
    v_mfma_f32_32x32x16_bf16 v[40:55], v[84:87], v[4:7], 0
    ds_read_b128 v[80:83], v104 offset:40960
    buffer_load_dwordx4 v[168:171], v2, s[48:51], s65 offen offset:0 sc1
    v_exp_f32 v30, v30
    v_exp_f32 v31, v31
    v_exp_f32 v32, v32
    v_exp_f32 v33, v33
    v_exp_f32 v34, v34
    v_exp_f32 v35, v35
    v_smfmac_f32_32x32x32_bf16 v[64:79], v[88:91], v[24:31], v56
    buffer_load_dwordx4 v[172:175], v2, s[48:51], s65 offen offset:1024 sc1
    v_exp_f32 v36, v36
    v_exp_f32 v37, v37
    v_exp_f32 v38, v38
    v_exp_f32 v39, v39
    v_exp_f32 v40, v40
    v_exp_f32 v41, v41
    v_smfmac_f32_32x32x32_bf16 v[64:79], v[92:95], v[32:39], v56
    s_mov_b64 exec, s[6:7]
    ds_read_b128 v[88:91], v105 offset:40960
    ds_read_b128 v[92:95], v105 offset:41472
    s_mov_b64 exec, -1
    v_exp_f32 v42, v42
    v_exp_f32 v43, v43
    v_exp_f32 v44, v44
    v_exp_f32 v45, v45
    s_waitcnt lgkmcnt(2)
    v_mfma_f32_32x32x16_bf16 v[24:39], v[80:83], v[4:7], 0
    ds_read_b128 v[84:87], v104 offset:43008
    buffer_load_dwordx4 v[176:179], v2, s[48:51], s65 offen offset:2048 sc1
    v_exp_f32 v46, v46
    v_exp_f32 v47, v47
    v_exp_f32 v48, v48
    v_exp_f32 v49, v49
    v_exp_f32 v50, v50
    v_exp_f32 v51, v51
    v_smfmac_f32_32x32x32_bf16 v[64:79], v[96:99], v[40:47], v56
    buffer_load_dwordx4 v[180:183], v2, s[48:51], s65 offen offset:3072 sc1
    s_add_u32 s65, s65, 4096
    v_exp_f32 v52, v52
    v_exp_f32 v53, v53
    v_exp_f32 v54, v54
    v_exp_f32 v55, v55
    v_exp_f32 v24, v24
    v_exp_f32 v25, v25
    v_smfmac_f32_32x32x32_bf16 v[64:79], v[100:103], v[48:55], v56
    s_mov_b64 exec, s[6:7]
    ds_read_b128 v[96:99], v105 offset:43008
    ds_read_b128 v[100:103], v105 offset:43520
    s_mov_b64 exec, -1
    v_exp_f32 v26, v26
    v_exp_f32 v27, v27
    v_exp_f32 v28, v28
    v_exp_f32 v29, v29
    s_waitcnt lgkmcnt(2)
    v_mfma_f32_32x32x16_bf16 v[40:55], v[84:87], v[4:7], 0
    ds_read_b128 v[80:83], v104 offset:45056
    buffer_load_dwordx4 v[184:187], v2, s[48:51], s65 offen offset:0 sc1
    v_exp_f32 v30, v30
    v_exp_f32 v31, v31
    v_exp_f32 v32, v32
    v_exp_f32 v33, v33
    v_exp_f32 v34, v34
    v_exp_f32 v35, v35
    v_smfmac_f32_32x32x32_bf16 v[64:79], v[88:91], v[24:31], v56
    buffer_load_dwordx4 v[188:191], v2, s[48:51], s65 offen offset:1024 sc1
    v_exp_f32 v36, v36
    v_exp_f32 v37, v37
    v_exp_f32 v38, v38
    v_exp_f32 v39, v39
    v_exp_f32 v40, v40
    v_exp_f32 v41, v41
    v_smfmac_f32_32x32x32_bf16 v[64:79], v[92:95], v[32:39], v56
    s_mov_b64 exec, s[6:7]
    ds_read_b128 v[88:91], v105 offset:45056
    ds_read_b128 v[92:95], v105 offset:45568
    s_mov_b64 exec, -1
    v_exp_f32 v42, v42
    v_exp_f32 v43, v43
    v_exp_f32 v44, v44
    v_exp_f32 v45, v45
    s_waitcnt lgkmcnt(2)
    v_mfma_f32_32x32x16_bf16 v[24:39], v[80:83], v[4:7], 0
    ds_read_b128 v[84:87], v104 offset:47104
    buffer_load_dwordx4 v[192:195], v2, s[48:51], s65 offen offset:2048 sc1
    v_exp_f32 v46, v46
    v_exp_f32 v47, v47
    v_exp_f32 v48, v48
    v_exp_f32 v49, v49
    v_exp_f32 v50, v50
    v_exp_f32 v51, v51
    v_smfmac_f32_32x32x32_bf16 v[64:79], v[96:99], v[40:47], v56
    buffer_load_dwordx4 v[196:199], v2, s[48:51], s65 offen offset:3072 sc1
    s_add_u32 s65, s65, 4096
    v_exp_f32 v52, v52
    v_exp_f32 v53, v53
    v_exp_f32 v54, v54
    v_exp_f32 v55, v55
    s_lshl_b32 s92, s57, 2
    s_lshl_b32 s93, s62, 1
    s_add_u32 s92, s92, s93
    s_add_u32 s92, s92, s90
    s_lshl_b32 s92, s92, 1
    s_add_u32 s92, s92, s63
    s_lshl_b32 s93, s92, 10
    s_lshl_b32 s94, s58, 16
    s_add_u32 s70, s93, s94
    s_lshr_b32 s93, s92, 1
    s_lshl_b32 s95, s63, 5
    s_add_u32 s93, s93, s95
    s_lshl_b32 s93, s93, 8
    s_lshl_b32 s95, s58, 14
    s_add_u32 s93, s93, s95
    s_add_u32 s72, s93, 393216
    s_mul_i32 s92, s57, 7
    s_add_u32 s92, s92, s56
    s_min_u32 s92, s92, 55
    s_lshl_b32 s93, s92, 12
    s_mul_i32 s94, s58, 229376
    s_add_u32 s93, s93, s94
    s_add_u32 s71, s93, 5242880
    v_exp_f32 v24, v24
    v_exp_f32 v25, v25
    v_smfmac_f32_32x32x32_bf16 v[64:79], v[100:103], v[48:55], v56
    s_mov_b64 exec, s[6:7]
    ds_read_b128 v[96:99], v105 offset:47104
    ds_read_b128 v[100:103], v105 offset:47616
    s_mov_b64 exec, -1
    v_exp_f32 v26, v26
    v_exp_f32 v27, v27
    v_exp_f32 v28, v28
    v_exp_f32 v29, v29
    s_waitcnt lgkmcnt(2)
    v_mfma_f32_32x32x16_bf16 v[40:55], v[84:87], v[4:7], 0
    ds_read_b128 v[80:83], v104 offset:49152
    buffer_load_dwordx4 v[200:203], v2, s[48:51], s65 offen offset:0 sc1
    v_exp_f32 v30, v30
    v_exp_f32 v31, v31
    v_exp_f32 v32, v32
    v_exp_f32 v33, v33
    v_exp_f32 v34, v34
    v_exp_f32 v35, v35
    v_smfmac_f32_32x32x32_bf16 v[64:79], v[88:91], v[24:31], v56
    buffer_load_dwordx4 v[204:207], v2, s[48:51], s65 offen offset:1024 sc1
    v_exp_f32 v36, v36
    v_exp_f32 v37, v37
    v_exp_f32 v38, v38
    v_exp_f32 v39, v39
    s_add_u32 s92, s70, 1048576
    buffer_load_dwordx4 v[148:151], v2, s[48:51], s92 offen sc1
    v_exp_f32 v40, v40
    v_exp_f32 v41, v41
    v_smfmac_f32_32x32x32_bf16 v[64:79], v[92:95], v[32:39], v56
    s_mov_b64 exec, s[6:7]
    ds_read_b128 v[88:91], v105 offset:49152
    ds_read_b128 v[92:95], v105 offset:49664
    s_mov_b64 exec, -1
    v_exp_f32 v42, v42
    v_exp_f32 v43, v43
    v_exp_f32 v44, v44
    v_exp_f32 v45, v45
    s_waitcnt lgkmcnt(2)
    v_mfma_f32_32x32x16_bf16 v[24:39], v[80:83], v[4:7], 0
    ds_read_b128 v[84:87], v104 offset:51200
    buffer_load_dwordx4 v[208:211], v2, s[48:51], s65 offen offset:2048 sc1
    v_exp_f32 v46, v46
    v_exp_f32 v47, v47
    v_exp_f32 v48, v48
    v_exp_f32 v49, v49
    v_exp_f32 v50, v50
    v_exp_f32 v51, v51
    v_smfmac_f32_32x32x32_bf16 v[64:79], v[96:99], v[40:47], v56
    buffer_load_dwordx4 v[212:215], v2, s[48:51], s65 offen offset:3072 sc1
    s_add_u32 s65, s65, 4096
    v_exp_f32 v52, v52
    v_exp_f32 v53, v53
    v_exp_f32 v54, v54
    v_exp_f32 v55, v55
    s_add_u32 s92, s70, 3145728
    buffer_load_dwordx4 v[148:151], v2, s[48:51], s92 offen sc1
    v_exp_f32 v24, v24
    v_exp_f32 v25, v25
    v_smfmac_f32_32x32x32_bf16 v[64:79], v[100:103], v[48:55], v56
    s_mov_b64 exec, s[6:7]
    ds_read_b128 v[96:99], v105 offset:51200
    ds_read_b128 v[100:103], v105 offset:51712
    s_mov_b64 exec, -1
    v_exp_f32 v26, v26
    v_exp_f32 v27, v27
    v_exp_f32 v28, v28
    v_exp_f32 v29, v29
    s_waitcnt lgkmcnt(2)
    v_mfma_f32_32x32x16_bf16 v[40:55], v[84:87], v[4:7], 0
    ds_read_b128 v[80:83], v104 offset:53248
    buffer_load_dwordx4 v[216:219], v2, s[48:51], s65 offen offset:0 sc1
    v_exp_f32 v30, v30
    v_exp_f32 v31, v31
    v_exp_f32 v32, v32
    v_exp_f32 v33, v33
    v_exp_f32 v34, v34
    v_exp_f32 v35, v35
    v_smfmac_f32_32x32x32_bf16 v[64:79], v[88:91], v[24:31], v56
    buffer_load_dwordx4 v[220:223], v2, s[48:51], s65 offen offset:1024 sc1
    v_exp_f32 v36, v36
    v_exp_f32 v37, v37
    v_exp_f32 v38, v38
    v_exp_f32 v39, v39
    s_mov_b64 exec, 0xffff
    buffer_load_dwordx4 v[148:151], v2, s[48:51], s72 offen sc1
    s_cmp_eq_u32 s56, 7
    s_cbranch_scc0 L_ptf_11
    s_lshl_b32 s93, s58, 8
    s_add_u32 s92, s93, 16384
    buffer_load_dwordx4 v[148:151], v2, s[48:51], s92 offen sc1
    s_add_u32 s92, s93, 24576
    buffer_load_dwordx4 v[148:151], v2, s[48:51], s92 offen sc1
    s_add_u32 s92, s93, 32768
    buffer_load_dwordx4 v[148:151], v2, s[48:51], s92 offen sc1
L_ptf_11:
    s_mov_b64 exec, -1
    v_exp_f32 v40, v40
    v_exp_f32 v41, v41
    v_smfmac_f32_32x32x32_bf16 v[64:79], v[92:95], v[32:39], v56
    s_mov_b64 exec, s[6:7]
    ds_read_b128 v[88:91], v105 offset:53248
    ds_read_b128 v[92:95], v105 offset:53760
    s_mov_b64 exec, -1
    v_exp_f32 v42, v42
    v_exp_f32 v43, v43
    v_exp_f32 v44, v44
    v_exp_f32 v45, v45
    s_waitcnt lgkmcnt(2)
    v_mfma_f32_32x32x16_bf16 v[24:39], v[80:83], v[4:7], 0
    ds_read_b128 v[84:87], v104 offset:55296
    buffer_load_dwordx4 v[224:227], v2, s[48:51], s65 offen offset:2048 sc1
    v_exp_f32 v46, v46
    v_exp_f32 v47, v47
    v_exp_f32 v48, v48
    v_exp_f32 v49, v49
    v_exp_f32 v50, v50
    v_exp_f32 v51, v51
    v_smfmac_f32_32x32x32_bf16 v[64:79], v[96:99], v[40:47], v56
    buffer_load_dwordx4 v[228:231], v2, s[48:51], s65 offen offset:3072 sc1
    s_add_u32 s65, s65, 4096
    v_exp_f32 v52, v52
    v_exp_f32 v53, v53
    v_exp_f32 v54, v54
    v_exp_f32 v55, v55
    s_cmp_eq_u32 s56, 7
    s_cbranch_scc1 L_pth_12
    buffer_load_dwordx4 v[148:151], v2, s[48:51], s71 offen offset:0 sc1
L_pth_12:
    v_exp_f32 v24, v24
    v_exp_f32 v25, v25
    v_smfmac_f32_32x32x32_bf16 v[64:79], v[100:103], v[48:55], v56
    s_mov_b64 exec, s[6:7]
    ds_read_b128 v[96:99], v105 offset:55296
    ds_read_b128 v[100:103], v105 offset:55808
    s_mov_b64 exec, -1
    v_exp_f32 v26, v26
    v_exp_f32 v27, v27
    v_exp_f32 v28, v28
    v_exp_f32 v29, v29
    s_waitcnt lgkmcnt(2)
    v_mfma_f32_32x32x16_bf16 v[40:55], v[84:87], v[4:7], 0
    ds_read_b128 v[80:83], v104 offset:57344
    buffer_load_dwordx4 v[232:235], v2, s[48:51], s65 offen offset:0 sc1
    v_exp_f32 v30, v30
    v_exp_f32 v31, v31
    v_exp_f32 v32, v32
    v_exp_f32 v33, v33
    v_exp_f32 v34, v34
    v_exp_f32 v35, v35
    v_smfmac_f32_32x32x32_bf16 v[64:79], v[88:91], v[24:31], v56
    buffer_load_dwordx4 v[236:239], v2, s[48:51], s65 offen offset:1024 sc1
    v_exp_f32 v36, v36
    v_exp_f32 v37, v37
    v_exp_f32 v38, v38
    v_exp_f32 v39, v39
    s_cmp_eq_u32 s56, 7
    s_cbranch_scc1 L_pth_13
    buffer_load_dwordx4 v[148:151], v2, s[48:51], s71 offen offset:1024 sc1
L_pth_13:
    v_exp_f32 v40, v40
    v_exp_f32 v41, v41
    v_smfmac_f32_32x32x32_bf16 v[64:79], v[92:95], v[32:39], v56
    s_mov_b64 exec, s[6:7]
    ds_read_b128 v[88:91], v105 offset:57344
    ds_read_b128 v[92:95], v105 offset:57856
    s_mov_b64 exec, -1
    v_exp_f32 v42, v42
    v_exp_f32 v43, v43
    v_exp_f32 v44, v44
    v_exp_f32 v45, v45
    s_waitcnt lgkmcnt(2)
    v_mfma_f32_32x32x16_bf16 v[24:39], v[80:83], v[4:7], 0
    ds_read_b128 v[84:87], v104 offset:59392
    buffer_load_dwordx4 v[240:243], v2, s[48:51], s65 offen offset:2048 sc1
    v_exp_f32 v46, v46
    v_exp_f32 v47, v47
    v_exp_f32 v48, v48
    v_exp_f32 v49, v49
    v_exp_f32 v50, v50
    v_exp_f32 v51, v51
    v_smfmac_f32_32x32x32_bf16 v[64:79], v[96:99], v[40:47], v56
    buffer_load_dwordx4 v[244:247], v2, s[48:51], s65 offen offset:3072 sc1
    s_add_u32 s65, s65, 4096
    v_exp_f32 v52, v52
    v_exp_f32 v53, v53
    v_exp_f32 v54, v54
    v_exp_f32 v55, v55
    s_cmp_eq_u32 s56, 7
    s_cbranch_scc1 L_pth_14
    buffer_load_dwordx4 v[148:151], v2, s[48:51], s71 offen offset:2048 sc1
L_pth_14:
    v_exp_f32 v24, v24
    v_exp_f32 v25, v25
    v_smfmac_f32_32x32x32_bf16 v[64:79], v[100:103], v[48:55], v56
    s_mov_b64 exec, s[6:7]
    ds_read_b128 v[96:99], v105 offset:59392
    ds_read_b128 v[100:103], v105 offset:59904
    s_mov_b64 exec, -1
    v_exp_f32 v26, v26
    v_exp_f32 v27, v27
    v_exp_f32 v28, v28
    v_exp_f32 v29, v29
    s_waitcnt lgkmcnt(2)
    v_mfma_f32_32x32x16_bf16 v[40:55], v[84:87], v[4:7], 0
    ds_read_b128 v[80:83], v104 offset:61440
    buffer_load_dwordx4 v[248:251], v2, s[48:51], s65 offen offset:0 sc1
    v_exp_f32 v30, v30
    v_exp_f32 v31, v31
    v_exp_f32 v32, v32
    v_exp_f32 v33, v33
    v_exp_f32 v34, v34
    v_exp_f32 v35, v35
    v_smfmac_f32_32x32x32_bf16 v[64:79], v[88:91], v[24:31], v56
    buffer_load_dwordx4 v[252:255], v2, s[48:51], s65 offen offset:1024 sc1
    v_exp_f32 v36, v36
    v_exp_f32 v37, v37
    v_exp_f32 v38, v38
    v_exp_f32 v39, v39
    s_cmp_eq_u32 s56, 7
    s_cbranch_scc1 L_pth_15
    buffer_load_dwordx4 v[148:151], v2, s[48:51], s71 offen offset:3072 sc1
L_pth_15:
    v_exp_f32 v40, v40
    v_exp_f32 v41, v41
    v_smfmac_f32_32x32x32_bf16 v[64:79], v[92:95], v[32:39], v56
    s_mov_b64 exec, s[6:7]
    ds_read_b128 v[88:91], v105 offset:61440
    ds_read_b128 v[92:95], v105 offset:61952
    s_mov_b64 exec, -1
    v_exp_f32 v42, v42
    v_exp_f32 v43, v43
    v_exp_f32 v44, v44
    v_exp_f32 v45, v45
    s_waitcnt lgkmcnt(2)
    v_mfma_f32_32x32x16_bf16 v[24:39], v[80:83], v[4:7], 0
    ds_read_b128 v[84:87], v104 offset:63488
    buffer_load_dwordx4 v[8:11], v57, s[48:51], s66 offen offset:0 sc1
    v_exp_f32 v46, v46
    v_exp_f32 v47, v47
    v_exp_f32 v48, v48
    v_exp_f32 v49, v49
    v_exp_f32 v50, v50
    v_exp_f32 v51, v51
    v_smfmac_f32_32x32x32_bf16 v[64:79], v[96:99], v[40:47], v56
    buffer_load_dwordx4 v[12:15], v57, s[48:51], s66 offen offset:1024 sc1
    v_exp_f32 v52, v52
    v_exp_f32 v53, v53
    v_exp_f32 v54, v54
    v_exp_f32 v55, v55
    s_cmp_eq_u32 s90, 0
    s_cbranch_scc0 L_swA_16
    s_setprio 0
L_swA_16:
    v_exp_f32 v24, v24
    v_exp_f32 v25, v25
    v_smfmac_f32_32x32x32_bf16 v[64:79], v[100:103], v[48:55], v56
    s_mov_b64 exec, s[6:7]
    ds_read_b128 v[96:99], v105 offset:63488
    ds_read_b128 v[100:103], v105 offset:64000
    s_mov_b64 exec, -1
    v_exp_f32 v26, v26
    v_exp_f32 v27, v27
    v_exp_f32 v28, v28
    v_exp_f32 v29, v29
    s_waitcnt lgkmcnt(2)
    v_mfma_f32_32x32x16_bf16 v[40:55], v[84:87], v[4:7], 0
    ds_read_b128 v[80:83], v106 offset:32768
    buffer_load_dwordx4 v[16:19], v57, s[48:51], s66 offen offset:2048 sc1
    v_exp_f32 v30, v30
    v_exp_f32 v31, v31
    v_exp_f32 v32, v32
    v_exp_f32 v33, v33
    v_exp_f32 v34, v34
    v_exp_f32 v35, v35
    v_smfmac_f32_32x32x32_bf16 v[64:79], v[88:91], v[24:31], v56
    buffer_load_dwordx4 v[20:23], v57, s[48:51], s66 offen offset:3072 sc1
    s_add_u32 s66, s66, 4096
    v_exp_f32 v36, v36
    v_exp_f32 v37, v37
    v_exp_f32 v38, v38
    v_exp_f32 v39, v39
    v_exp_f32 v40, v40
    v_exp_f32 v41, v41
    v_smfmac_f32_32x32x32_bf16 v[64:79], v[92:95], v[32:39], v56
    s_mov_b64 exec, s[6:7]
    ds_read_b128 v[88:91], v107 offset:32768
    ds_read_b128 v[92:95], v107 offset:33280
    s_mov_b64 exec, -1
    v_exp_f32 v42, v42
    v_exp_f32 v43, v43
    v_exp_f32 v44, v44
    v_exp_f32 v45, v45
    s_waitcnt lgkmcnt(2)
    v_mfma_f32_32x32x16_bf16 v[24:39], v[80:83], v[4:7], 0
    ds_read_b128 v[84:87], v106 offset:34816
    buffer_load_dwordx4 v[60:63], v57, s[48:51], s66 offen offset:0 sc1
    v_exp_f32 v46, v46
    v_exp_f32 v47, v47
    v_exp_f32 v48, v48
    v_exp_f32 v49, v49
    v_exp_f32 v50, v50
    v_exp_f32 v51, v51
    v_smfmac_f32_32x32x32_bf16 v[64:79], v[96:99], v[40:47], v56
    buffer_load_dwordx4 v[108:111], v57, s[48:51], s66 offen offset:1024 sc1
    v_exp_f32 v52, v52
    v_exp_f32 v53, v53
    v_exp_f32 v54, v54
    v_exp_f32 v55, v55
    v_exp_f32 v24, v24
    v_exp_f32 v25, v25
    v_smfmac_f32_32x32x32_bf16 v[64:79], v[100:103], v[48:55], v56
    s_mov_b64 exec, s[6:7]
    ds_read_b128 v[96:99], v107 offset:34816
    ds_read_b128 v[100:103], v107 offset:35328
    s_mov_b64 exec, -1
    v_exp_f32 v26, v26
    v_exp_f32 v27, v27
    v_exp_f32 v28, v28
    v_exp_f32 v29, v29
    s_waitcnt lgkmcnt(2)
    v_mfma_f32_32x32x16_bf16 v[40:55], v[84:87], v[4:7], 0
    ds_read_b128 v[80:83], v106 offset:36864
    buffer_load_dwordx4 v[112:115], v57, s[48:51], s66 offen offset:2048 sc1
    v_exp_f32 v30, v30
    v_exp_f32 v31, v31
    v_exp_f32 v32, v32
    v_exp_f32 v33, v33
    v_exp_f32 v34, v34
    v_exp_f32 v35, v35
    v_smfmac_f32_32x32x32_bf16 v[64:79], v[88:91], v[24:31], v56
    buffer_load_dwordx4 v[116:119], v57, s[48:51], s66 offen offset:3072 sc1
    s_add_u32 s66, s66, 4096
    v_exp_f32 v36, v36
    v_exp_f32 v37, v37
    v_exp_f32 v38, v38
    v_exp_f32 v39, v39
    v_exp_f32 v40, v40
    v_exp_f32 v41, v41
    v_smfmac_f32_32x32x32_bf16 v[64:79], v[92:95], v[32:39], v56
    s_mov_b64 exec, s[6:7]
    ds_read_b128 v[88:91], v107 offset:36864
    ds_read_b128 v[92:95], v107 offset:37376
    s_mov_b64 exec, -1
    v_exp_f32 v42, v42
    v_exp_f32 v43, v43
    v_exp_f32 v44, v44
    v_exp_f32 v45, v45
    s_waitcnt lgkmcnt(2)
    v_mfma_f32_32x32x16_bf16 v[24:39], v[80:83], v[4:7], 0
    ds_read_b128 v[84:87], v106 offset:38912
    buffer_load_dwordx4 v[120:123], v57, s[48:51], s66 offen offset:0 sc1
    v_exp_f32 v46, v46
    v_exp_f32 v47, v47
    v_exp_f32 v48, v48
    v_exp_f32 v49, v49
    v_exp_f32 v50, v50
    v_exp_f32 v51, v51
    v_smfmac_f32_32x32x32_bf16 v[64:79], v[96:99], v[40:47], v56
    buffer_load_dwordx4 v[124:127], v57, s[48:51], s66 offen offset:1024 sc1
    v_exp_f32 v52, v52
    v_exp_f32 v53, v53
    v_exp_f32 v54, v54
    v_exp_f32 v55, v55
    v_exp_f32 v24, v24
    v_exp_f32 v25, v25
    v_smfmac_f32_32x32x32_bf16 v[64:79], v[100:103], v[48:55], v56
    s_mov_b64 exec, s[6:7]
    ds_read_b128 v[96:99], v107 offset:38912
    ds_read_b128 v[100:103], v107 offset:39424
    s_mov_b64 exec, -1
    v_exp_f32 v26, v26
    v_exp_f32 v27, v27
    v_exp_f32 v28, v28
    v_exp_f32 v29, v29
    s_waitcnt lgkmcnt(2)
    v_mfma_f32_32x32x16_bf16 v[40:55], v[84:87], v[4:7], 0
    ds_read_b128 v[80:83], v106 offset:40960
    buffer_load_dwordx4 v[128:131], v57, s[48:51], s66 offen offset:2048 sc1
    v_exp_f32 v30, v30
    v_exp_f32 v31, v31
    v_exp_f32 v32, v32
    v_exp_f32 v33, v33
    v_exp_f32 v34, v34
    v_exp_f32 v35, v35
    v_smfmac_f32_32x32x32_bf16 v[64:79], v[88:91], v[24:31], v56
    buffer_load_dwordx4 v[132:135], v57, s[48:51], s66 offen offset:3072 sc1
    s_add_u32 s66, s66, 4096
    v_exp_f32 v36, v36
    v_exp_f32 v37, v37
    v_exp_f32 v38, v38
    v_exp_f32 v39, v39
    v_exp_f32 v40, v40
    v_exp_f32 v41, v41
    v_smfmac_f32_32x32x32_bf16 v[64:79], v[92:95], v[32:39], v56
    s_mov_b64 exec, s[6:7]
    ds_read_b128 v[88:91], v107 offset:40960
    ds_read_b128 v[92:95], v107 offset:41472
    s_mov_b64 exec, -1
    v_exp_f32 v42, v42
    v_exp_f32 v43, v43
    v_exp_f32 v44, v44
    v_exp_f32 v45, v45
    s_waitcnt lgkmcnt(2)
    v_mfma_f32_32x32x16_bf16 v[24:39], v[80:83], v[4:7], 0
    ds_read_b128 v[84:87], v106 offset:43008
    buffer_load_dwordx4 v[136:139], v57, s[48:51], s66 offen offset:0 sc1
    v_exp_f32 v46, v46
    v_exp_f32 v47, v47
    v_exp_f32 v48, v48
    v_exp_f32 v49, v49
    v_exp_f32 v50, v50
    v_exp_f32 v51, v51
    v_smfmac_f32_32x32x32_bf16 v[64:79], v[96:99], v[40:47], v56
    buffer_load_dwordx4 v[140:143], v57, s[48:51], s66 offen offset:1024 sc1
    v_exp_f32 v52, v52
    v_exp_f32 v53, v53
    v_exp_f32 v54, v54
    v_exp_f32 v55, v55
    v_exp_f32 v24, v24
    v_exp_f32 v25, v25
    v_smfmac_f32_32x32x32_bf16 v[64:79], v[100:103], v[48:55], v56
    s_mov_b64 exec, s[6:7]
    ds_read_b128 v[96:99], v107 offset:43008
    ds_read_b128 v[100:103], v107 offset:43520
    s_mov_b64 exec, -1
    v_exp_f32 v26, v26
    v_exp_f32 v27, v27
    v_exp_f32 v28, v28
    v_exp_f32 v29, v29
    s_waitcnt lgkmcnt(2)
    v_mfma_f32_32x32x16_bf16 v[40:55], v[84:87], v[4:7], 0
    ds_read_b128 v[80:83], v106 offset:45056
    buffer_load_dwordx4 v[144:147], v57, s[48:51], s66 offen offset:2048 sc1
    v_exp_f32 v30, v30
    v_exp_f32 v31, v31
    v_exp_f32 v32, v32
    v_exp_f32 v33, v33
    v_exp_f32 v34, v34
    v_exp_f32 v35, v35
    v_smfmac_f32_32x32x32_bf16 v[64:79], v[88:91], v[24:31], v56
    buffer_load_dwordx4 v[148:151], v57, s[48:51], s66 offen offset:3072 sc1
    v_exp_f32 v36, v36
    v_exp_f32 v37, v37
    v_exp_f32 v38, v38
    v_exp_f32 v39, v39
    v_exp_f32 v40, v40
    v_exp_f32 v41, v41
    v_smfmac_f32_32x32x32_bf16 v[64:79], v[92:95], v[32:39], v56
    s_mov_b64 exec, s[6:7]
    ds_read_b128 v[88:91], v107 offset:45056
    ds_read_b128 v[92:95], v107 offset:45568
    s_mov_b64 exec, -1
    v_exp_f32 v42, v42
    v_exp_f32 v43, v43
    v_exp_f32 v44, v44
    v_exp_f32 v45, v45
    s_waitcnt lgkmcnt(2)
    v_mfma_f32_32x32x16_bf16 v[24:39], v[80:83], v[4:7], 0
    ds_read_b128 v[84:87], v106 offset:47104
    v_exp_f32 v46, v46
    v_exp_f32 v47, v47
    v_exp_f32 v48, v48
    v_exp_f32 v49, v49
    v_exp_f32 v50, v50
    v_exp_f32 v51, v51
    v_smfmac_f32_32x32x32_bf16 v[64:79], v[96:99], v[40:47], v56
    v_exp_f32 v52, v52
    v_exp_f32 v53, v53
    v_exp_f32 v54, v54
    v_exp_f32 v55, v55
    v_exp_f32 v24, v24
    v_exp_f32 v25, v25
    v_smfmac_f32_32x32x32_bf16 v[64:79], v[100:103], v[48:55], v56
    s_mov_b64 exec, s[6:7]
    ds_read_b128 v[96:99], v107 offset:47104
    ds_read_b128 v[100:103], v107 offset:47616
    s_mov_b64 exec, -1
    v_exp_f32 v26, v26
    v_exp_f32 v27, v27
    v_exp_f32 v28, v28
    v_exp_f32 v29, v29
    s_waitcnt lgkmcnt(2)
    v_mfma_f32_32x32x16_bf16 v[40:55], v[84:87], v[4:7], 0
    ds_read_b128 v[80:83], v106 offset:49152
    v_exp_f32 v30, v30
    v_exp_f32 v31, v31
    v_exp_f32 v32, v32
    v_exp_f32 v33, v33
    v_exp_f32 v34, v34
    v_exp_f32 v35, v35
    v_smfmac_f32_32x32x32_bf16 v[64:79], v[88:91], v[24:31], v56
    v_exp_f32 v36, v36
    v_exp_f32 v37, v37
    v_exp_f32 v38, v38
    v_exp_f32 v39, v39
    v_exp_f32 v40, v40
    v_exp_f32 v41, v41
    v_smfmac_f32_32x32x32_bf16 v[64:79], v[92:95], v[32:39], v56
    s_mov_b64 exec, s[6:7]
    ds_read_b128 v[88:91], v107 offset:49152
    ds_read_b128 v[92:95], v107 offset:49664
    s_mov_b64 exec, -1
    v_exp_f32 v42, v42
    v_exp_f32 v43, v43
    v_exp_f32 v44, v44
    v_exp_f32 v45, v45
    s_waitcnt lgkmcnt(2)
    v_mfma_f32_32x32x16_bf16 v[24:39], v[80:83], v[4:7], 0
    ds_read_b128 v[84:87], v106 offset:51200
    v_exp_f32 v46, v46
    v_exp_f32 v47, v47
    v_exp_f32 v48, v48
    v_exp_f32 v49, v49
    v_exp_f32 v50, v50
    v_exp_f32 v51, v51
    v_smfmac_f32_32x32x32_bf16 v[64:79], v[96:99], v[40:47], v56
    v_exp_f32 v52, v52
    v_exp_f32 v53, v53
    v_exp_f32 v54, v54
    v_exp_f32 v55, v55
    v_exp_f32 v24, v24
    v_exp_f32 v25, v25
    v_smfmac_f32_32x32x32_bf16 v[64:79], v[100:103], v[48:55], v56
    s_mov_b64 exec, s[6:7]
    ds_read_b128 v[96:99], v107 offset:51200
    ds_read_b128 v[100:103], v107 offset:51712
    s_mov_b64 exec, -1
    v_exp_f32 v26, v26
    v_exp_f32 v27, v27
    v_exp_f32 v28, v28
    v_exp_f32 v29, v29
    s_waitcnt lgkmcnt(2)
    v_mfma_f32_32x32x16_bf16 v[40:55], v[84:87], v[4:7], 0
    ds_read_b128 v[80:83], v106 offset:53248
    v_exp_f32 v30, v30
    v_exp_f32 v31, v31
    v_exp_f32 v32, v32
    v_exp_f32 v33, v33
    v_exp_f32 v34, v34
    v_exp_f32 v35, v35
    v_smfmac_f32_32x32x32_bf16 v[64:79], v[88:91], v[24:31], v56
    v_exp_f32 v36, v36
    v_exp_f32 v37, v37
    v_exp_f32 v38, v38
    v_exp_f32 v39, v39
    v_exp_f32 v40, v40
    v_exp_f32 v41, v41
    v_smfmac_f32_32x32x32_bf16 v[64:79], v[92:95], v[32:39], v56
    s_mov_b64 exec, s[6:7]
    ds_read_b128 v[88:91], v107 offset:53248
    ds_read_b128 v[92:95], v107 offset:53760
    s_mov_b64 exec, -1
    v_exp_f32 v42, v42
    v_exp_f32 v43, v43
    v_exp_f32 v44, v44
    v_exp_f32 v45, v45
    s_waitcnt lgkmcnt(2)
    v_mfma_f32_32x32x16_bf16 v[24:39], v[80:83], v[4:7], 0
    ds_read_b128 v[84:87], v106 offset:55296
    v_exp_f32 v46, v46
    v_exp_f32 v47, v47
    v_exp_f32 v48, v48
    v_exp_f32 v49, v49
    v_exp_f32 v50, v50
    v_exp_f32 v51, v51
    v_smfmac_f32_32x32x32_bf16 v[64:79], v[96:99], v[40:47], v56
    v_exp_f32 v52, v52
    v_exp_f32 v53, v53
    v_exp_f32 v54, v54
    v_exp_f32 v55, v55
    v_exp_f32 v24, v24
    v_exp_f32 v25, v25
    v_smfmac_f32_32x32x32_bf16 v[64:79], v[100:103], v[48:55], v56
    s_mov_b64 exec, s[6:7]
    ds_read_b128 v[96:99], v107 offset:55296
    ds_read_b128 v[100:103], v107 offset:55808
    s_mov_b64 exec, -1
    v_exp_f32 v26, v26
    v_exp_f32 v27, v27
    v_exp_f32 v28, v28
    v_exp_f32 v29, v29
    s_waitcnt lgkmcnt(2)
    v_mfma_f32_32x32x16_bf16 v[40:55], v[84:87], v[4:7], 0
    ds_read_b128 v[80:83], v106 offset:57344
    v_exp_f32 v30, v30
    v_exp_f32 v31, v31
    v_exp_f32 v32, v32
    v_exp_f32 v33, v33
    v_exp_f32 v34, v34
    v_exp_f32 v35, v35
    v_smfmac_f32_32x32x32_bf16 v[64:79], v[88:91], v[24:31], v56
    v_exp_f32 v36, v36
    v_exp_f32 v37, v37
    v_exp_f32 v38, v38
    v_exp_f32 v39, v39
    v_exp_f32 v40, v40
    v_exp_f32 v41, v41
    v_smfmac_f32_32x32x32_bf16 v[64:79], v[92:95], v[32:39], v56
    s_mov_b64 exec, s[6:7]
    ds_read_b128 v[88:91], v107 offset:57344
    ds_read_b128 v[92:95], v107 offset:57856
    s_mov_b64 exec, -1
    v_exp_f32 v42, v42
    v_exp_f32 v43, v43
    v_exp_f32 v44, v44
    v_exp_f32 v45, v45
    s_waitcnt lgkmcnt(2)
    v_mfma_f32_32x32x16_bf16 v[24:39], v[80:83], v[4:7], 0
    ds_read_b128 v[84:87], v106 offset:59392
    v_exp_f32 v46, v46
    v_exp_f32 v47, v47
    v_exp_f32 v48, v48
    v_exp_f32 v49, v49
    v_exp_f32 v50, v50
    v_exp_f32 v51, v51
    v_smfmac_f32_32x32x32_bf16 v[64:79], v[96:99], v[40:47], v56
    v_exp_f32 v52, v52
    v_exp_f32 v53, v53
    v_exp_f32 v54, v54
    v_exp_f32 v55, v55
    v_exp_f32 v24, v24
    v_exp_f32 v25, v25
    v_smfmac_f32_32x32x32_bf16 v[64:79], v[100:103], v[48:55], v56
    s_mov_b64 exec, s[6:7]
    ds_read_b128 v[96:99], v107 offset:59392
    ds_read_b128 v[100:103], v107 offset:59904
    s_mov_b64 exec, -1
    v_exp_f32 v26, v26
    v_exp_f32 v27, v27
    v_exp_f32 v28, v28
    v_exp_f32 v29, v29
    s_waitcnt lgkmcnt(2)
    v_mfma_f32_32x32x16_bf16 v[40:55], v[84:87], v[4:7], 0
    ds_read_b128 v[80:83], v106 offset:61440
    v_exp_f32 v30, v30
    v_exp_f32 v31, v31
    v_exp_f32 v32, v32
    v_exp_f32 v33, v33
    v_exp_f32 v34, v34
    v_exp_f32 v35, v35
    v_smfmac_f32_32x32x32_bf16 v[64:79], v[88:91], v[24:31], v56
    v_exp_f32 v36, v36
    v_exp_f32 v37, v37
    v_exp_f32 v38, v38
    v_exp_f32 v39, v39
    v_exp_f32 v40, v40
    v_exp_f32 v41, v41
    v_smfmac_f32_32x32x32_bf16 v[64:79], v[92:95], v[32:39], v56
    s_mov_b64 exec, s[6:7]
    ds_read_b128 v[88:91], v107 offset:61440
    ds_read_b128 v[92:95], v107 offset:61952
    s_mov_b64 exec, -1
    v_exp_f32 v42, v42
    v_exp_f32 v43, v43
    v_exp_f32 v44, v44
    v_exp_f32 v45, v45
    s_waitcnt lgkmcnt(2)
    v_mfma_f32_32x32x16_bf16 v[24:39], v[80:83], v[4:7], 0
    ds_read_b128 v[84:87], v106 offset:63488
    v_exp_f32 v46, v46
    v_exp_f32 v47, v47
    v_exp_f32 v48, v48
    v_exp_f32 v49, v49
    v_exp_f32 v50, v50
    v_exp_f32 v51, v51
    v_smfmac_f32_32x32x32_bf16 v[64:79], v[96:99], v[40:47], v56
    v_exp_f32 v52, v52
    v_exp_f32 v53, v53
    v_exp_f32 v54, v54
    v_exp_f32 v55, v55
    v_exp_f32 v24, v24
    v_exp_f32 v25, v25
    v_smfmac_f32_32x32x32_bf16 v[64:79], v[100:103], v[48:55], v56
    s_mov_b64 exec, s[6:7]
    ds_read_b128 v[96:99], v107 offset:63488
    ds_read_b128 v[100:103], v107 offset:64000
    s_mov_b64 exec, -1
    v_exp_f32 v26, v26
    v_exp_f32 v27, v27
    v_exp_f32 v28, v28
    v_exp_f32 v29, v29
    s_waitcnt lgkmcnt(2)
    v_mfma_f32_32x32x16_bf16 v[40:55], v[84:87], v[4:7], 0
    v_exp_f32 v30, v30
    v_exp_f32 v31, v31
    v_exp_f32 v32, v32
    v_exp_f32 v33, v33
    v_exp_f32 v34, v34
    v_exp_f32 v35, v35
    v_smfmac_f32_32x32x32_bf16 v[64:79], v[88:91], v[24:31], v56
    v_exp_f32 v36, v36
    v_exp_f32 v37, v37
    v_exp_f32 v38, v38
    v_exp_f32 v39, v39
    s_nop 0
    v_exp_f32 v40, v40
    v_exp_f32 v41, v41
    v_smfmac_f32_32x32x32_bf16 v[64:79], v[92:95], v[32:39], v56
    v_exp_f32 v42, v42
    v_exp_f32 v43, v43
    v_exp_f32 v44, v44
    v_exp_f32 v45, v45
    v_exp_f32 v46, v46
    v_exp_f32 v47, v47
    v_exp_f32 v48, v48
    v_exp_f32 v49, v49
    v_exp_f32 v50, v50
    v_exp_f32 v51, v51
    s_waitcnt lgkmcnt(0)
    v_smfmac_f32_32x32x32_bf16 v[64:79], v[96:99], v[40:47], v56
    v_exp_f32 v52, v52
    v_exp_f32 v53, v53
    v_exp_f32 v54, v54
    v_exp_f32 v55, v55
    s_nop 1
    v_smfmac_f32_32x32x32_bf16 v[64:79], v[100:103], v[48:55], v56
    s_setprio 0
    s_nop 7
    s_nop 3
    v_rcp_f32 v3, v72
    v_mul_f32 v80, 0, v64
    v_mul_f32 v81, 0, v65
    v_fma_f32 v80, v66, 0, v80
    v_fma_f32 v81, v67, 0, v81
    v_fma_f32 v80, v68, 0, v80
    v_fma_f32 v81, v69, 0, v81
    v_fma_f32 v80, v70, 0, v80
    v_fma_f32 v81, v71, 0, v81
    v_add_f32 v80, v80, v81
    v_cmp_u_f32 vcc, v80, v80
    s_nop 0
    s_cmp_lg_u64 vcc, 0
    s_cselect_b32 s92, 1, 0
    s_or_b32 s92, s92, s97
    s_cmp_eq_u32 s92, 0
    s_cbranch_scc1 L_nofb
    v_mov_b32 v57, v104
    v_mov_b32 v58, 0xff800000
    s_mov_b32 s98, 64
L_fb:
    ds_read_b128 v[80:83], v57
    v_add_u32 v57, 2048, v57
    s_waitcnt lgkmcnt(0)
    v_mfma_f32_32x32x16_bf16 v[24:39], v[80:83], v[4:7], 0
    s_nop 11
    v_max3_f32 v58, v24, v25, v58
    v_max3_f32 v58, v26, v27, v58
    v_max3_f32 v58, v28, v29, v58
    v_max3_f32 v58, v30, v31, v58
    v_max3_f32 v58, v32, v33, v58
    v_max3_f32 v58, v34, v35, v58
    v_max3_f32 v58, v36, v37, v58
    v_max3_f32 v58, v38, v39, v58
    s_sub_u32 s98, s98, 1
    s_cmp_lg_u32 s98, 0
    s_cbranch_scc1 L_fb
    v_mov_b32 v57, v58
    s_nop 1
    v_permlane32_swap_b32 v57, v58
    v_max_f32 v58, v57, v58
    v_sub_f32 v40, 0, v58
    v_mov_b32 v41, v40
    v_mov_b32 v42, v40
    v_mov_b32 v43, v40
    v_mov_b32 v44, v40
    v_mov_b32 v45, v40
    v_mov_b32 v46, v40
    v_mov_b32 v47, v40
    v_mov_b32 v48, v40
    v_mov_b32 v49, v40
    v_mov_b32 v50, v40
    v_mov_b32 v51, v40
    v_mov_b32 v52, v40
    v_mov_b32 v53, v40
    v_mov_b32 v54, v40
    v_mov_b32 v55, v40
    v_mov_b32 v64, 0
    v_mov_b32 v65, 0
    v_mov_b32 v66, 0
    v_mov_b32 v67, 0
    v_mov_b32 v68, 0
    v_mov_b32 v69, 0
    v_mov_b32 v70, 0
    v_mov_b32 v71, 0
    v_mov_b32 v72, 0
    v_mov_b32 v73, 0
    v_mov_b32 v74, 0
    v_mov_b32 v75, 0
    v_mov_b32 v76, 0
    v_mov_b32 v77, 0
    v_mov_b32 v78, 0
    v_mov_b32 v79, 0
    v_mov_b32 v57, v104
    v_mov_b32 v58, v105
    s_mov_b32 s98, 64
L_fb2:
    ds_read_b128 v[80:83], v57
    s_mov_b64 exec, s[6:7]
    ds_read_b128 v[88:91], v58
    ds_read_b128 v[92:95], v58 offset:512
    s_mov_b64 exec, -1
    v_add_u32 v57, 2048, v57
    v_add_u32 v58, 2048, v58
    s_waitcnt lgkmcnt(0)
    v_mfma_f32_32x32x16_bf16 v[24:39], v[80:83], v[4:7], v[40:55]
    s_nop 11
    v_exp_f32 v24, v24
    v_exp_f32 v25, v25
    v_exp_f32 v26, v26
    v_exp_f32 v27, v27
    v_exp_f32 v28, v28
    v_exp_f32 v29, v29
    v_exp_f32 v30, v30
    v_exp_f32 v31, v31
    v_exp_f32 v32, v32
    v_exp_f32 v33, v33
    v_exp_f32 v34, v34
    v_exp_f32 v35, v35
    v_exp_f32 v36, v36
    v_exp_f32 v37, v37
    v_exp_f32 v38, v38
    v_exp_f32 v39, v39
    v_smfmac_f32_32x32x32_bf16 v[64:79], v[88:91], v[24:31], v56
    s_nop 0
    v_smfmac_f32_32x32x32_bf16 v[64:79], v[92:95], v[32:39], v56
    s_sub_u32 s98, s98, 1
    s_cmp_lg_u32 s98, 0
    s_nop 7
    s_nop 7
    s_cbranch_scc1 L_fb2
    v_rcp_f32 v3, v72
L_nofb:
    s_nop 0
    v_mul_f32 v64, v3, v64
    v_mul_f32 v65, v3, v65
    v_mul_f32 v66, v3, v66
    v_mul_f32 v67, v3, v67
    v_mul_f32 v68, v3, v68
    v_mul_f32 v69, v3, v69
    v_mul_f32 v70, v3, v70
    v_mul_f32 v71, v3, v71
    v_cvt_pk_bf16_f32 v40, v64, v65
    v_cvt_pk_bf16_f32 v41, v66, v67
    v_cvt_pk_bf16_f32 v42, v68, v69
    v_cvt_pk_bf16_f32 v43, v70, v71
    s_lshl_b32 s88, s57, 2
    s_lshl_b32 s93, s62, 1
    s_add_u32 s88, s88, s93
    s_add_u32 s88, s88, s90
    s_lshl_b32 s93, s88, 1
    s_add_u32 s93, s93, s63
    s_lshl_b32 s93, s93, 10
    s_lshl_b32 s94, s58, 16
    s_add_u32 s93, s93, s94
    s_add_u32 s93, s93, 1048576
    s_lshl_b32 s94, s63, 5
    s_add_u32 s94, s94, s88
    s_lshl_b32 s94, s94, 2
    s_lshl_b32 s95, s58, 8
    s_add_u32 s94, s94, s95
    s_add_u32 s94, s94, 16384
    v_mov_b32 v104, s3
    v_mov_b32 v105, 0
    s_cmp_eq_u32 s61, 0
    s_cbranch_scc0 L_pub_slow_o
    buffer_store_dwordx4 v[40:43], v2, s[48:51], s93 offen offset:0
    s_waitcnt vmcnt(0)
    s_mov_b64 exec, 1
    buffer_store_dword v104, v105, s[48:51], s94 offen
    s_mov_b64 exec, -1
    s_branch L_pub_done_o
L_pub_slow_o:
    buffer_store_dwordx4 v[40:43], v2, s[48:51], s93 offen offset:0 sc1
    s_waitcnt vmcnt(0)
    s_mov_b64 exec, 1
    buffer_store_dword v104, v105, s[48:51], s94 offen sc1
    s_mov_b64 exec, -1
L_pub_done_o:
    v_and_b32 v3, 31, v1
    v_lshlrev_b32 v3, 10, v3
    v_lshrrev_b32 v104, 5, v1
    v_lshl_or_b32 v3, v104, 3, v3
    s_lshl_b32 s92, s63, 5
    s_add_u32 s92, s92, s59
    s_lshl_b32 s92, s92, 10
    s_lshl_b32 s93, s88, 5
    s_add_u32 s92, s92, s93
    buffer_load_dwordx2 v[56:57], v3, s[8:11], s92 offen
    buffer_load_dwordx2 v[58:59], v3, s[8:11], s92 offen offset:16
    s_cmp_lt_u32 s56, 4
    s_cbranch_scc0 L_nocsA
    s_mov_b32 s5, 0x3f803f80
    v_dot2_f32_bf16 v106, v152, s5, 0
    v_dot2_f32_bf16 v107, v153, s5, 0
    v_dot2_f32_bf16 v106, v154, s5, v106
    v_dot2_f32_bf16 v107, v155, s5, v107
    v_dot2_f32_bf16 v106, v156, s5, v106
    v_dot2_f32_bf16 v107, v157, s5, v107
    v_dot2_f32_bf16 v106, v158, s5, v106
    v_dot2_f32_bf16 v107, v159, s5, v107
    v_dot2_f32_bf16 v106, v160, s5, v106
    v_dot2_f32_bf16 v107, v161, s5, v107
    v_dot2_f32_bf16 v106, v162, s5, v106
    v_dot2_f32_bf16 v107, v163, s5, v107
    v_dot2_f32_bf16 v106, v164, s5, v106
    v_dot2_f32_bf16 v107, v165, s5, v107
    v_dot2_f32_bf16 v106, v166, s5, v106
    v_dot2_f32_bf16 v107, v167, s5, v107
    v_dot2_f32_bf16 v106, v168, s5, v106
    v_dot2_f32_bf16 v107, v169, s5, v107
    v_dot2_f32_bf16 v106, v170, s5, v106
    v_dot2_f32_bf16 v107, v171, s5, v107
    v_dot2_f32_bf16 v106, v172, s5, v106
    v_dot2_f32_bf16 v107, v173, s5, v107
    v_dot2_f32_bf16 v106, v174, s5, v106
    v_dot2_f32_bf16 v107, v175, s5, v107
    v_dot2_f32_bf16 v106, v176, s5, v106
    v_dot2_f32_bf16 v107, v177, s5, v107
    v_dot2_f32_bf16 v106, v178, s5, v106
    v_dot2_f32_bf16 v107, v179, s5, v107
    v_dot2_f32_bf16 v106, v180, s5, v106
    v_dot2_f32_bf16 v107, v181, s5, v107
    v_dot2_f32_bf16 v106, v182, s5, v106
    v_dot2_f32_bf16 v107, v183, s5, v107
    v_dot2_f32_bf16 v106, v184, s5, v106
    v_dot2_f32_bf16 v107, v185, s5, v107
    v_dot2_f32_bf16 v106, v186, s5, v106
    v_dot2_f32_bf16 v107, v187, s5, v107
    v_dot2_f32_bf16 v106, v188, s5, v106
    v_dot2_f32_bf16 v107, v189, s5, v107
    v_dot2_f32_bf16 v106, v190, s5, v106
    v_dot2_f32_bf16 v107, v191, s5, v107
    v_dot2_f32_bf16 v106, v192, s5, v106
    v_dot2_f32_bf16 v107, v193, s5, v107
    v_dot2_f32_bf16 v106, v194, s5, v106
    v_dot2_f32_bf16 v107, v195, s5, v107
    v_dot2_f32_bf16 v106, v196, s5, v106
    v_dot2_f32_bf16 v107, v197, s5, v107
    v_dot2_f32_bf16 v106, v198, s5, v106
    v_dot2_f32_bf16 v107, v199, s5, v107
    v_dot2_f32_bf16 v106, v200, s5, v106
    v_dot2_f32_bf16 v107, v201, s5, v107
    v_dot2_f32_bf16 v106, v202, s5, v106
    v_dot2_f32_bf16 v107, v203, s5, v107
    v_dot2_f32_bf16 v106, v204, s5, v106
    v_dot2_f32_bf16 v107, v205, s5, v107
    v_dot2_f32_bf16 v106, v206, s5, v106
    v_dot2_f32_bf16 v107, v207, s5, v107
    v_dot2_f32_bf16 v106, v208, s5, v106
    v_dot2_f32_bf16 v107, v209, s5, v107
    v_dot2_f32_bf16 v106, v210, s5, v106
    v_dot2_f32_bf16 v107, v211, s5, v107
    v_dot2_f32_bf16 v106, v212, s5, v106
    v_dot2_f32_bf16 v107, v213, s5, v107
    v_dot2_f32_bf16 v106, v214, s5, v106
    v_dot2_f32_bf16 v107, v215, s5, v107
    v_dot2_f32_bf16 v106, v216, s5, v106
    v_dot2_f32_bf16 v107, v217, s5, v107
    v_dot2_f32_bf16 v106, v218, s5, v106
    v_dot2_f32_bf16 v107, v219, s5, v107
    v_dot2_f32_bf16 v106, v220, s5, v106
    v_dot2_f32_bf16 v107, v221, s5, v107
    v_dot2_f32_bf16 v106, v222, s5, v106
    v_dot2_f32_bf16 v107, v223, s5, v107
    v_dot2_f32_bf16 v106, v224, s5, v106
    v_dot2_f32_bf16 v107, v225, s5, v107
    v_dot2_f32_bf16 v106, v226, s5, v106
    v_dot2_f32_bf16 v107, v227, s5, v107
    v_dot2_f32_bf16 v106, v228, s5, v106
    v_dot2_f32_bf16 v107, v229, s5, v107
    v_dot2_f32_bf16 v106, v230, s5, v106
    v_dot2_f32_bf16 v107, v231, s5, v107
    v_dot2_f32_bf16 v106, v232, s5, v106
    v_dot2_f32_bf16 v107, v233, s5, v107
    v_dot2_f32_bf16 v106, v234, s5, v106
    v_dot2_f32_bf16 v107, v235, s5, v107
    v_dot2_f32_bf16 v106, v236, s5, v106
    v_dot2_f32_bf16 v107, v237, s5, v107
    v_dot2_f32_bf16 v106, v238, s5, v106
    v_dot2_f32_bf16 v107, v239, s5, v107
    v_dot2_f32_bf16 v106, v240, s5, v106
    v_dot2_f32_bf16 v107, v241, s5, v107
    v_dot2_f32_bf16 v106, v242, s5, v106
    v_dot2_f32_bf16 v107, v243, s5, v107
    v_dot2_f32_bf16 v106, v244, s5, v106
    v_dot2_f32_bf16 v107, v245, s5, v107
    v_dot2_f32_bf16 v106, v246, s5, v106
    v_dot2_f32_bf16 v107, v247, s5, v107
    v_dot2_f32_bf16 v106, v248, s5, v106
    v_dot2_f32_bf16 v107, v249, s5, v107
    v_dot2_f32_bf16 v106, v250, s5, v106
    v_dot2_f32_bf16 v107, v251, s5, v107
    v_dot2_f32_bf16 v106, v252, s5, v106
    v_dot2_f32_bf16 v107, v253, s5, v107
    v_dot2_f32_bf16 v106, v254, s5, v106
    v_dot2_f32_bf16 v107, v255, s5, v107
L_nocsA:
    s_barrier
    s_lshl_b32 s92, s63, 5
    s_lshl_b32 s93, s90, 4
    s_add_u32 s92, s92, s93
    s_lshl_b32 s92, s92, 2
    s_lshl_b32 s93, s58, 8
    s_add_u32 s92, s92, s93
    s_add_u32 s92, s92, 16384
    v_and_b32 v3, 15, v1
    v_lshlrev_b32 v3, 2, v3
    s_mov_b32 s67, s92
    buffer_load_dword v104, v3, s[48:51], s67 offen sc1
    s_cmp_lt_u32 s56, 4
    s_cbranch_scc1 L_nocs_b1
    s_cmp_eq_u32 s56, 7
    s_cbranch_scc1 L_nocs_b1
    s_mov_b32 s5, 0x3f803f80
    v_dot2_f32_bf16 v106, v152, s5, 0
    v_dot2_f32_bf16 v107, v153, s5, 0
    v_dot2_f32_bf16 v106, v154, s5, v106
    v_dot2_f32_bf16 v107, v155, s5, v107
    v_dot2_f32_bf16 v106, v156, s5, v106
    v_dot2_f32_bf16 v107, v157, s5, v107
    v_dot2_f32_bf16 v106, v158, s5, v106
    v_dot2_f32_bf16 v107, v159, s5, v107
    v_dot2_f32_bf16 v106, v160, s5, v106
    v_dot2_f32_bf16 v107, v161, s5, v107
    v_dot2_f32_bf16 v106, v162, s5, v106
    v_dot2_f32_bf16 v107, v163, s5, v107
    v_dot2_f32_bf16 v106, v164, s5, v106
    v_dot2_f32_bf16 v107, v165, s5, v107
    v_dot2_f32_bf16 v106, v166, s5, v106
    v_dot2_f32_bf16 v107, v167, s5, v107
    v_dot2_f32_bf16 v106, v168, s5, v106
    v_dot2_f32_bf16 v107, v169, s5, v107
    v_dot2_f32_bf16 v106, v170, s5, v106
    v_dot2_f32_bf16 v107, v171, s5, v107
    v_dot2_f32_bf16 v106, v172, s5, v106
    v_dot2_f32_bf16 v107, v173, s5, v107
    v_dot2_f32_bf16 v106, v174, s5, v106
    v_dot2_f32_bf16 v107, v175, s5, v107
    v_dot2_f32_bf16 v106, v176, s5, v106
    v_dot2_f32_bf16 v107, v177, s5, v107
    v_dot2_f32_bf16 v106, v178, s5, v106
    v_dot2_f32_bf16 v107, v179, s5, v107
    v_dot2_f32_bf16 v106, v180, s5, v106
    v_dot2_f32_bf16 v107, v181, s5, v107
    v_dot2_f32_bf16 v106, v182, s5, v106
    v_dot2_f32_bf16 v107, v183, s5, v107
    v_dot2_f32_bf16 v106, v184, s5, v106
    v_dot2_f32_bf16 v107, v185, s5, v107
    v_dot2_f32_bf16 v106, v186, s5, v106
    v_dot2_f32_bf16 v107, v187, s5, v107
    v_dot2_f32_bf16 v106, v188, s5, v106
    v_dot2_f32_bf16 v107, v189, s5, v107
    v_dot2_f32_bf16 v106, v190, s5, v106
    v_dot2_f32_bf16 v107, v191, s5, v107
    v_dot2_f32_bf16 v106, v192, s5, v106
    v_dot2_f32_bf16 v107, v193, s5, v107
    v_dot2_f32_bf16 v106, v194, s5, v106
    v_dot2_f32_bf16 v107, v195, s5, v107
    v_dot2_f32_bf16 v106, v196, s5, v106
    v_dot2_f32_bf16 v107, v197, s5, v107
    v_dot2_f32_bf16 v106, v198, s5, v106
    v_dot2_f32_bf16 v107, v199, s5, v107
    v_dot2_f32_bf16 v106, v200, s5, v106
    v_dot2_f32_bf16 v107, v201, s5, v107
    v_dot2_f32_bf16 v106, v202, s5, v106
    v_dot2_f32_bf16 v107, v203, s5, v107
L_nocs_b1:
    s_mov_b32 s98, 200000
L_poll_o:
    s_waitcnt vmcnt(0)
    v_cmp_ne_u32 vcc, s3, v104
    s_nop 0
    s_cbranch_vccz L_pollok_o
    s_sub_u32 s98, s98, 1
    s_cmp_eq_u32 s98, 0
    s_cbranch_scc1 L_pollok_o
    s_sleep 1
    buffer_load_dword v104, v3, s[48:51], s67 offen sc1
    s_branch L_poll_o
L_pollok_o:
    s_lshl_b32 s92, s90, 4
    s_lshl_b32 s93, s62, 2
    s_add_u32 s92, s92, s93
    s_lshl_b32 s92, s92, 1
    s_add_u32 s92, s92, s63
    s_lshl_b32 s92, s92, 10
    s_lshl_b32 s93, s58, 16
    s_add_u32 s93, s93, s92
    s_add_u32 s93, s93, 1048576
    s_add_u32 s94, s92, 0
    s_add_u32 s95, s93, 0
    s_mov_b32 m0, s94
    s_nop 0
    buffer_load_dwordx4 v2, s[48:51], s95 offen sc1 lds
    s_add_u32 s94, s92, 2048
    s_add_u32 s95, s93, 2048
    s_mov_b32 m0, s94
    s_nop 0
    buffer_load_dwordx4 v2, s[48:51], s95 offen sc1 lds
    s_add_u32 s94, s92, 4096
    s_add_u32 s95, s93, 4096
    s_mov_b32 m0, s94
    s_nop 0
    buffer_load_dwordx4 v2, s[48:51], s95 offen sc1 lds
    s_add_u32 s94, s92, 6144
    s_add_u32 s95, s93, 6144
    s_mov_b32 m0, s94
    s_nop 0
    buffer_load_dwordx4 v2, s[48:51], s95 offen sc1 lds
    s_mov_b32 s67, s92
    s_mov_b32 s68, s93
    s_cmp_lt_u32 s56, 4
    s_cbranch_scc1 L_nocs_b2
    s_cmp_eq_u32 s56, 7
    s_cbranch_scc1 L_nocs_b2
    s_mov_b32 s5, 0x3f803f80
    v_dot2_f32_bf16 v106, v204, s5, v106
    v_dot2_f32_bf16 v107, v205, s5, v107
    v_dot2_f32_bf16 v106, v206, s5, v106
    v_dot2_f32_bf16 v107, v207, s5, v107
    v_dot2_f32_bf16 v106, v208, s5, v106
    v_dot2_f32_bf16 v107, v209, s5, v107
    v_dot2_f32_bf16 v106, v210, s5, v106
    v_dot2_f32_bf16 v107, v211, s5, v107
    v_dot2_f32_bf16 v106, v212, s5, v106
    v_dot2_f32_bf16 v107, v213, s5, v107
    v_dot2_f32_bf16 v106, v214, s5, v106
    v_dot2_f32_bf16 v107, v215, s5, v107
    v_dot2_f32_bf16 v106, v216, s5, v106
    v_dot2_f32_bf16 v107, v217, s5, v107
    v_dot2_f32_bf16 v106, v218, s5, v106
    v_dot2_f32_bf16 v107, v219, s5, v107
    v_dot2_f32_bf16 v106, v220, s5, v106
    v_dot2_f32_bf16 v107, v221, s5, v107
    v_dot2_f32_bf16 v106, v222, s5, v106
    v_dot2_f32_bf16 v107, v223, s5, v107
    v_dot2_f32_bf16 v106, v224, s5, v106
    v_dot2_f32_bf16 v107, v225, s5, v107
    v_dot2_f32_bf16 v106, v226, s5, v106
    v_dot2_f32_bf16 v107, v227, s5, v107
    v_dot2_f32_bf16 v106, v228, s5, v106
    v_dot2_f32_bf16 v107, v229, s5, v107
    v_dot2_f32_bf16 v106, v230, s5, v106
    v_dot2_f32_bf16 v107, v231, s5, v107
    v_dot2_f32_bf16 v106, v232, s5, v106
    v_dot2_f32_bf16 v107, v233, s5, v107
    v_dot2_f32_bf16 v106, v234, s5, v106
    v_dot2_f32_bf16 v107, v235, s5, v107
    v_dot2_f32_bf16 v106, v236, s5, v106
    v_dot2_f32_bf16 v107, v237, s5, v107
    v_dot2_f32_bf16 v106, v238, s5, v106
    v_dot2_f32_bf16 v107, v239, s5, v107
    v_dot2_f32_bf16 v106, v240, s5, v106
    v_dot2_f32_bf16 v107, v241, s5, v107
    v_dot2_f32_bf16 v106, v242, s5, v106
    v_dot2_f32_bf16 v107, v243, s5, v107
    v_dot2_f32_bf16 v106, v244, s5, v106
    v_dot2_f32_bf16 v107, v245, s5, v107
    v_dot2_f32_bf16 v106, v246, s5, v106
    v_dot2_f32_bf16 v107, v247, s5, v107
    v_dot2_f32_bf16 v106, v248, s5, v106
    v_dot2_f32_bf16 v107, v249, s5, v107
    v_dot2_f32_bf16 v106, v250, s5, v106
    v_dot2_f32_bf16 v107, v251, s5, v107
    v_dot2_f32_bf16 v106, v252, s5, v106
    v_dot2_f32_bf16 v107, v253, s5, v107
    v_dot2_f32_bf16 v106, v254, s5, v106
    v_dot2_f32_bf16 v107, v255, s5, v107
L_nocs_b2:
    s_mov_b32 s92, s67
    s_mov_b32 s93, s68
    s_waitcnt vmcnt(2)
    s_add_u32 s94, s92, 16384
    s_add_u32 s95, s93, 16384
    s_mov_b32 m0, s94
    s_nop 0
    buffer_load_dwordx4 v2, s[48:51], s95 offen sc1 lds
    s_add_u32 s94, s92, 18432
    s_add_u32 s95, s93, 18432
    s_mov_b32 m0, s94
    s_nop 0
    buffer_load_dwordx4 v2, s[48:51], s95 offen sc1 lds
    s_add_u32 s94, s92, 20480
    s_add_u32 s95, s93, 20480
    s_mov_b32 m0, s94
    s_nop 0
    buffer_load_dwordx4 v2, s[48:51], s95 offen sc1 lds
    s_add_u32 s94, s92, 22528
    s_add_u32 s95, s93, 22528
    s_mov_b32 m0, s94
    s_nop 0
    buffer_load_dwordx4 v2, s[48:51], s95 offen sc1 lds
    s_lshl_b32 s92, s90, 15
    s_lshl_b32 s93, s63, 10
    s_add_u32 s92, s92, s93
    v_add_u32 v104, s92, v2
    s_waitcnt vmcnt(4)
    s_barrier
    ds_read_b128 v[64:67], v104 offset:0
    ds_read_b128 v[68:71], v104 offset:2048
    ds_read_b128 v[72:75], v104 offset:4096
    ds_read_b128 v[76:79], v104 offset:6144
    ds_read_b128 v[80:83], v104 offset:8192
    ds_read_b128 v[84:87], v104 offset:10240
    ds_read_b128 v[88:91], v104 offset:12288
    ds_read_b128 v[92:95], v104 offset:14336
    s_waitcnt lgkmcnt(7)
    v_mfma_f32_32x32x16_bf16 v[24:39], v[8:11], v[64:67], 0
    s_waitcnt lgkmcnt(6)
    v_mfma_f32_32x32x16_bf16 v[24:39], v[12:15], v[68:71], v[24:39]
    s_waitcnt lgkmcnt(5)
    v_mfma_f32_32x32x16_bf16 v[24:39], v[16:19], v[72:75], v[24:39]
    s_waitcnt lgkmcnt(4)
    v_mfma_f32_32x32x16_bf16 v[24:39], v[20:23], v[76:79], v[24:39]
    s_waitcnt lgkmcnt(3)
    v_mfma_f32_32x32x16_bf16 v[24:39], v[60:63], v[80:83], v[24:39]
    s_waitcnt lgkmcnt(2)
    v_mfma_f32_32x32x16_bf16 v[24:39], v[108:111], v[84:87], v[24:39]
    s_waitcnt lgkmcnt(1)
    v_mfma_f32_32x32x16_bf16 v[24:39], v[112:115], v[88:91], v[24:39]
    s_waitcnt lgkmcnt(0)
    v_mfma_f32_32x32x16_bf16 v[24:39], v[116:119], v[92:95], v[24:39]
    s_waitcnt vmcnt(0)
    s_barrier
    ds_read_b128 v[64:67], v104 offset:16384
    ds_read_b128 v[68:71], v104 offset:18432
    ds_read_b128 v[72:75], v104 offset:20480
    ds_read_b128 v[76:79], v104 offset:22528
    ds_read_b128 v[80:83], v104 offset:24576
    ds_read_b128 v[84:87], v104 offset:26624
    ds_read_b128 v[88:91], v104 offset:28672
    ds_read_b128 v[92:95], v104 offset:30720
    buffer_load_dwordx4 v[40:43], v2, s[48:51], s65 offen offset:2048 sc1
    buffer_load_dwordx4 v[44:47], v2, s[48:51], s65 offen offset:3072 sc1
    s_add_u32 s65, s65, 4096
    buffer_load_dwordx4 v[48:51], v2, s[48:51], s65 offen offset:0 sc1
    buffer_load_dwordx4 v[52:55], v2, s[48:51], s65 offen offset:1024 sc1
    buffer_load_dwordx4 v[96:99], v2, s[48:51], s65 offen offset:2048 sc1
    buffer_load_dwordx4 v[100:103], v2, s[48:51], s65 offen offset:3072 sc1
    s_waitcnt lgkmcnt(7)
    v_mfma_f32_32x32x16_bf16 v[24:39], v[120:123], v[64:67], v[24:39]
    s_waitcnt lgkmcnt(6)
    v_mfma_f32_32x32x16_bf16 v[24:39], v[124:127], v[68:71], v[24:39]
    s_waitcnt lgkmcnt(5)
    v_mfma_f32_32x32x16_bf16 v[24:39], v[128:131], v[72:75], v[24:39]
    s_waitcnt lgkmcnt(4)
    v_mfma_f32_32x32x16_bf16 v[24:39], v[132:135], v[76:79], v[24:39]
    s_waitcnt lgkmcnt(3)
    v_mfma_f32_32x32x16_bf16 v[24:39], v[136:139], v[80:83], v[24:39]
    s_waitcnt lgkmcnt(2)
    v_mfma_f32_32x32x16_bf16 v[24:39], v[140:143], v[84:87], v[24:39]
    s_waitcnt lgkmcnt(1)
    v_mfma_f32_32x32x16_bf16 v[24:39], v[144:147], v[88:91], v[24:39]
    s_waitcnt lgkmcnt(0)
    v_mfma_f32_32x32x16_bf16 v[24:39], v[148:151], v[92:95], v[24:39]
    s_lshl_b32 s92, s56, 11
    s_add_u32 s92, s92, 131072
    v_add_u32 v104, s92, v2
    s_nop 8
    ds_write_b128 v104, v[32:35]
    ds_write_b128 v104, v[36:39] offset:1024
    s_waitcnt lgkmcnt(0)
    s_barrier
    v_xor_b32 v104, 8192, v104
    ds_read_b128 v[64:67], v104
    ds_read_b128 v[68:71], v104 offset:1024
    v_lshlrev_b32 v72, 16, v56
    v_and_b32 v73, 0xffff0000, v56
    v_lshlrev_b32 v74, 16, v57
    v_and_b32 v75, 0xffff0000, v57
    v_lshlrev_b32 v76, 16, v58
    v_and_b32 v77, 0xffff0000, v58
    v_lshlrev_b32 v78, 16, v59
    v_and_b32 v79, 0xffff0000, v59
    s_lshl_b32 s92, s88, 1
    s_add_u32 s92, s92, s63
    s_lshl_b32 s92, s92, 10
    s_lshl_b32 s93, s58, 16
    s_add_u32 s92, s92, s93
    s_add_u32 s92, s92, 3145728
    s_lshl_b32 s94, s63, 5
    s_add_u32 s94, s94, s88
    s_lshl_b32 s94, s94, 2
    s_lshl_b32 s95, s58, 8
    s_add_u32 s94, s94, s95
    s_add_u32 s94, s94, 24576
    v_add_f32 v24, v24, v72
    v_add_f32 v25, v25, v73
    v_add_f32 v26, v26, v74
    v_add_f32 v27, v27, v75
    v_add_f32 v28, v28, v76
    v_add_f32 v29, v29, v77
    v_add_f32 v30, v30, v78
    v_add_f32 v31, v31, v79
    s_waitcnt lgkmcnt(0)
    v_add_f32 v24, v24, v64
    v_add_f32 v25, v25, v65
    v_add_f32 v26, v26, v66
    v_add_f32 v27, v27, v67
    v_add_f32 v28, v28, v68
    v_add_f32 v29, v29, v69
    v_add_f32 v30, v30, v70
    v_add_f32 v31, v31, v71
    v_cvt_pk_bf16_f32 v4, v24, v25
    v_cvt_pk_bf16_f32 v5, v26, v27
    v_cvt_pk_bf16_f32 v6, v28, v29
    v_cvt_pk_bf16_f32 v7, v30, v31
    s_mov_b32 s5, 0x3f803f80
    v_dot2_f32_bf16 v56, v4, s5, 0
    v_dot2_f32_bf16 v57, v4, v4, 0
    v_dot2_f32_bf16 v56, v5, s5, v56
    v_dot2_f32_bf16 v57, v5, v5, v57
    v_dot2_f32_bf16 v56, v6, s5, v56
    v_dot2_f32_bf16 v57, v6, v6, v57
    v_dot2_f32_bf16 v56, v7, s5, v56
    v_dot2_f32_bf16 v57, v7, v7, v57
    s_nop 1
    v_mov_b32 v58, v56
    v_mov_b32 v59, v57
    s_nop 0
    v_permlane32_swap_b32 v56, v58
    v_permlane32_swap_b32 v57, v59
    v_add_f32 v56, v56, v58
    v_add_f32 v57, v57, v59
    s_lshl_b32 s93, s63, 5
    s_add_u32 s93, s93, s88
    s_lshl_b32 s93, s93, 8
    s_lshl_b32 s95, s58, 14
    s_add_u32 s93, s93, s95
    s_add_u32 s93, s93, 393216
    v_lshlrev_b32 v3, 3, v1
    v_mov_b32 v104, s3
    v_mov_b32 v105, 0
    s_cmp_eq_u32 s61, 0
    s_cbranch_scc0 L_pub_slow_h
    buffer_store_dwordx4 v[4:7], v2, s[48:51], s92 offen offset:0
    s_mov_b32 exec_hi, 0
    buffer_store_dwordx2 v[56:57], v3, s[48:51], s93 offen offset:0
    s_mov_b64 exec, -1
    s_waitcnt vmcnt(0)
    s_mov_b64 exec, 1
    buffer_store_dword v104, v105, s[48:51], s94 offen
    s_mov_b64 exec, -1
    s_branch L_pub_done_h
L_pub_slow_h:
    buffer_store_dwordx4 v[4:7], v2, s[48:51], s92 offen offset:0 sc1
    s_mov_b32 exec_hi, 0
    buffer_store_dwordx2 v[56:57], v3, s[48:51], s93 offen offset:0 sc1
    s_mov_b64 exec, -1
    s_waitcnt vmcnt(0)
    s_mov_b64 exec, 1
    buffer_store_dword v104, v105, s[48:51], s94 offen sc1
    s_mov_b64 exec, -1
L_pub_done_h:
    s_mul_i32 s92, s57, 224
    s_mul_i32 s93, s56, 14
    s_add_u32 s92, s92, s93
    s_lshl_b32 s92, s92, 10
    s_add_u32 s89, s92, 14942208
    s_add_u32 s92, s89, 0
    buffer_load_dwordx4 v[8:11], v2, s[48:51], s92 offen sc1
    s_add_u32 s92, s89, 1024
    buffer_load_dwordx4 v[12:15], v2, s[48:51], s92 offen sc1
    s_add_u32 s92, s89, 2048
    buffer_load_dwordx4 v[16:19], v2, s[48:51], s92 offen sc1
    s_add_u32 s92, s89, 3072
    buffer_load_dwordx4 v[20:23], v2, s[48:51], s92 offen sc1
    s_cmp_eq_u32 s56, 7
    s_cbranch_scc1 L_p4_pre7
    s_mov_b32 s5, 0x3f803f80
    v_dot2_f32_bf16 v106, v40, s5, v106
    v_dot2_f32_bf16 v107, v41, s5, v107
    v_dot2_f32_bf16 v106, v42, s5, v106
    v_dot2_f32_bf16 v107, v43, s5, v107
    v_dot2_f32_bf16 v106, v44, s5, v106
    v_dot2_f32_bf16 v107, v45, s5, v107
    v_dot2_f32_bf16 v106, v46, s5, v106
    v_dot2_f32_bf16 v107, v47, s5, v107
    v_dot2_f32_bf16 v106, v48, s5, v106
    v_dot2_f32_bf16 v107, v49, s5, v107
    v_dot2_f32_bf16 v106, v50, s5, v106
    v_dot2_f32_bf16 v107, v51, s5, v107
    v_dot2_f32_bf16 v106, v52, s5, v106
    v_dot2_f32_bf16 v107, v53, s5, v107
    v_dot2_f32_bf16 v106, v54, s5, v106
    v_dot2_f32_bf16 v107, v55, s5, v107
    v_dot2_f32_bf16 v106, v96, s5, v106
    v_dot2_f32_bf16 v107, v97, s5, v107
    v_dot2_f32_bf16 v106, v98, s5, v106
    v_dot2_f32_bf16 v107, v99, s5, v107
    v_dot2_f32_bf16 v106, v100, s5, v106
    v_dot2_f32_bf16 v107, v101, s5, v107
    v_dot2_f32_bf16 v106, v102, s5, v106
    v_dot2_f32_bf16 v107, v103, s5, v107
    s_nop 2
    v_add_f32 v106, v106, v107
    v_mov_b32 v107, v106
    s_nop 1
    v_permlane32_swap_b32 v106, v107
    v_add_f32 v106, v106, v107
    v_and_b32 v107, 31, v1
    v_lshlrev_b32 v107, 2, v107
    s_lshl_b32 s92, s56, 7
    s_add_u32 s92, s92, 148480
    v_add_u32 v107, s92, v107
    ds_write_b32 v107, v106
    s_branch L_p4_pre
L_p4_pre7:
    s_mul_i32 s92, s57, 448
    v_lshlrev_b32 v3, 3, v1
    v_min_u32 v3, 440, v3
    buffer_load_dwordx2 v[106:107], v3, s[36:39], s92 offen
    s_waitcnt vmcnt(0)
    v_lshlrev_b32 v108, 16, v106
    v_and_b32 v109, 0xffff0000, v106
    v_lshlrev_b32 v110, 16, v107
    v_and_b32 v111, 0xffff0000, v107
    v_mul_f32 v108, 0.5, v108
    v_mul_f32 v109, 0.5, v109
    v_mul_f32 v110, 0.5, v110
    v_mul_f32 v111, 0.5, v111
    v_lshlrev_b32 v3, 1, v3
    v_add_u32 v3, 149504, v3
    ds_write_b128 v3, v[108:111]
    s_nop 1
    v_mov_b32 v108, 0
    v_mov_b32 v109, 0
    v_mov_b32 v110, 0
    v_mov_b32 v111, 0
    v_mov_b32 v3, 150528
    s_mov_b64 exec, 1
    ds_write_b128 v3, v[108:111]
    s_mov_b64 exec, -1
L_p4_pre:
    s_lshl_b32 s92, s58, 8
    s_add_u32 s92, s92, 24576
    v_lshlrev_b32 v3, 2, v1
    s_mov_b32 s98, 200000
L_poll_h:
    buffer_load_dword v104, v3, s[48:51], s92 offen sc1
    s_waitcnt vmcnt(0)
    v_cmp_ne_u32 vcc, s3, v104
    s_nop 0
    s_cbranch_vccz L_pollok_h
    s_sub_u32 s98, s98, 1
    s_cmp_eq_u32 s98, 0
    s_cbranch_scc1 L_pollok_h
    s_sleep 1
    s_branch L_poll_h
L_pollok_h:
    s_lshl_b32 s67, s56, 11
    s_lshl_b32 s93, s58, 16
    s_add_u32 s93, s93, s67
    s_add_u32 s68, s93, 3145728
    s_add_u32 s94, s67, 65536
    s_add_u32 s95, s68, 0
    s_mov_b32 m0, s94
    s_nop 0
    buffer_load_dwordx4 v2, s[48:51], s95 offen sc1 lds
    s_add_u32 s94, s67, 66560
    s_add_u32 s95, s68, 1024
    s_mov_b32 m0, s94
    s_nop 0
    buffer_load_dwordx4 v2, s[48:51], s95 offen sc1 lds
    s_add_u32 s94, s67, 81920
    s_add_u32 s95, s68, 16384
    s_mov_b32 m0, s94
    s_nop 0
    buffer_load_dwordx4 v2, s[48:51], s95 offen sc1 lds
    s_add_u32 s94, s67, 82944
    s_add_u32 s95, s68, 17408
    s_mov_b32 m0, s94
    s_nop 0
    buffer_load_dwordx4 v2, s[48:51], s95 offen sc1 lds
    v_add_u32 v104, 65536, v2
    s_waitcnt vmcnt(2) lgkmcnt(0)
    s_barrier
    s_add_u32 s94, s67, 98304
    s_add_u32 s95, s68, 32768
    s_mov_b32 m0, s94
    s_nop 0
    buffer_load_dwordx4 v2, s[48:51], s95 offen sc1 lds
    s_add_u32 s94, s67, 99328
    s_add_u32 s95, s68, 33792
    s_mov_b32 m0, s94
    s_nop 0
    buffer_load_dwordx4 v2, s[48:51], s95 offen sc1 lds
    s_add_u32 s94, s67, 114688
    s_add_u32 s95, s68, 49152
    s_mov_b32 m0, s94
    s_nop 0
    buffer_load_dwordx4 v2, s[48:51], s95 offen sc1 lds
    s_add_u32 s94, s67, 115712
    s_add_u32 s95, s68, 50176
    s_mov_b32 m0, s94
    s_nop 0
    buffer_load_dwordx4 v2, s[48:51], s95 offen sc1 lds
    s_cmp_eq_u32 s56, 7
    s_cbranch_scc1 L_p4_w7
    ds_read_b128 v[108:111], v104 offset:0
    ds_read_b128 v[112:115], v104 offset:1024
    ds_read_b128 v[116:119], v104 offset:2048
    ds_read_b128 v[120:123], v104 offset:3072
    ds_read_b128 v[124:127], v104 offset:4096
    ds_read_b128 v[128:131], v104 offset:5120
    s_waitcnt lgkmcnt(4)
    v_mfma_f32_32x32x16_bf16 v[64:79], v[152:155], v[108:111], 0
    v_mfma_f32_32x32x16_bf16 v[80:95], v[152:155], v[112:115], 0
    ds_read_b128 v[108:111], v104 offset:6144
    ds_read_b128 v[112:115], v104 offset:7168
    s_waitcnt lgkmcnt(4)
    v_mfma_f32_32x32x16_bf16 v[64:79], v[156:159], v[116:119], v[64:79]
    v_mfma_f32_32x32x16_bf16 v[80:95], v[156:159], v[120:123], v[80:95]
    s_add_u32 s92, s89, 4096
    buffer_load_dwordx4 v[24:27], v2, s[48:51], s92 offen sc1
    ds_read_b128 v[116:119], v104 offset:8192
    ds_read_b128 v[120:123], v104 offset:9216
    s_waitcnt lgkmcnt(4)
    v_mfma_f32_32x32x16_bf16 v[64:79], v[160:163], v[124:127], v[64:79]
    v_mfma_f32_32x32x16_bf16 v[80:95], v[160:163], v[128:131], v[80:95]
    s_add_u32 s92, s89, 5120
    buffer_load_dwordx4 v[28:31], v2, s[48:51], s92 offen sc1
    ds_read_b128 v[124:127], v104 offset:10240
    ds_read_b128 v[128:131], v104 offset:11264
    s_waitcnt lgkmcnt(4)
    v_mfma_f32_32x32x16_bf16 v[64:79], v[164:167], v[108:111], v[64:79]
    v_mfma_f32_32x32x16_bf16 v[80:95], v[164:167], v[112:115], v[80:95]
    s_add_u32 s92, s89, 6144
    buffer_load_dwordx4 v[32:35], v2, s[48:51], s92 offen sc1
    ds_read_b128 v[108:111], v104 offset:12288
    ds_read_b128 v[112:115], v104 offset:13312
    s_waitcnt lgkmcnt(4)
    v_mfma_f32_32x32x16_bf16 v[64:79], v[168:171], v[116:119], v[64:79]
    v_mfma_f32_32x32x16_bf16 v[80:95], v[168:171], v[120:123], v[80:95]
    s_add_u32 s92, s89, 7168
    buffer_load_dwordx4 v[36:39], v2, s[48:51], s92 offen sc1
    ds_read_b128 v[116:119], v104 offset:14336
    ds_read_b128 v[120:123], v104 offset:15360
    s_waitcnt lgkmcnt(4)
    v_mfma_f32_32x32x16_bf16 v[64:79], v[172:175], v[124:127], v[64:79]
    v_mfma_f32_32x32x16_bf16 v[80:95], v[172:175], v[128:131], v[80:95]
    s_waitcnt vmcnt(8)
    s_barrier
    ds_read_b128 v[124:127], v104 offset:16384
    ds_read_b128 v[128:131], v104 offset:17408
    s_waitcnt lgkmcnt(4)
    v_mfma_f32_32x32x16_bf16 v[64:79], v[176:179], v[108:111], v[64:79]
    v_mfma_f32_32x32x16_bf16 v[80:95], v[176:179], v[112:115], v[80:95]
    s_add_u32 s92, s89, 8192
    buffer_load_dwordx4 v[56:59], v2, s[48:51], s92 offen sc1
    ds_read_b128 v[108:111], v104 offset:18432
    ds_read_b128 v[112:115], v104 offset:19456
    s_waitcnt lgkmcnt(4)
    v_mfma_f32_32x32x16_bf16 v[64:79], v[180:183], v[116:119], v[64:79]
    v_mfma_f32_32x32x16_bf16 v[80:95], v[180:183], v[120:123], v[80:95]
    s_add_u32 s92, s89, 9216
    buffer_load_dwordx4 v[60:63], v2, s[48:51], s92 offen sc1
    ds_read_b128 v[116:119], v104 offset:20480
    ds_read_b128 v[120:123], v104 offset:21504
    s_waitcnt lgkmcnt(4)
    v_mfma_f32_32x32x16_bf16 v[64:79], v[184:187], v[124:127], v[64:79]
    v_mfma_f32_32x32x16_bf16 v[80:95], v[184:187], v[128:131], v[80:95]
    s_add_u32 s92, s89, 10240
    buffer_load_dwordx4 v[132:135], v2, s[48:51], s92 offen sc1
    ds_read_b128 v[124:127], v104 offset:22528
    ds_read_b128 v[128:131], v104 offset:23552
    s_waitcnt lgkmcnt(4)
    v_mfma_f32_32x32x16_bf16 v[64:79], v[188:191], v[108:111], v[64:79]
    v_mfma_f32_32x32x16_bf16 v[80:95], v[188:191], v[112:115], v[80:95]
    s_add_u32 s92, s89, 11264
    buffer_load_dwordx4 v[136:139], v2, s[48:51], s92 offen sc1
    ds_read_b128 v[108:111], v104 offset:24576
    ds_read_b128 v[112:115], v104 offset:25600
    s_waitcnt lgkmcnt(4)
    v_mfma_f32_32x32x16_bf16 v[64:79], v[192:195], v[116:119], v[64:79]
    v_mfma_f32_32x32x16_bf16 v[80:95], v[192:195], v[120:123], v[80:95]
    ds_read_b128 v[116:119], v104 offset:26624
    ds_read_b128 v[120:123], v104 offset:27648
    s_waitcnt lgkmcnt(4)
    v_mfma_f32_32x32x16_bf16 v[64:79], v[196:199], v[124:127], v[64:79]
    v_mfma_f32_32x32x16_bf16 v[80:95], v[196:199], v[128:131], v[80:95]
    s_add_u32 s92, s89, 12288
    buffer_load_dwordx4 v[140:143], v2, s[48:51], s92 offen sc1
    ds_read_b128 v[124:127], v104 offset:28672
    ds_read_b128 v[128:131], v104 offset:29696
    s_waitcnt lgkmcnt(4)
    v_mfma_f32_32x32x16_bf16 v[64:79], v[200:203], v[108:111], v[64:79]
    v_mfma_f32_32x32x16_bf16 v[80:95], v[200:203], v[112:115], v[80:95]
    s_add_u32 s92, s89, 13312
    buffer_load_dwordx4 v[144:147], v2, s[48:51], s92 offen sc1
    ds_read_b128 v[108:111], v104 offset:30720
    ds_read_b128 v[112:115], v104 offset:31744
    s_waitcnt lgkmcnt(4)
    v_mfma_f32_32x32x16_bf16 v[64:79], v[204:207], v[116:119], v[64:79]
    v_mfma_f32_32x32x16_bf16 v[80:95], v[204:207], v[120:123], v[80:95]
    s_add_u32 s92, s89, 114688
    buffer_load_dwordx4 v[152:155], v2, s[48:51], s92 offen sc1
    s_waitcnt vmcnt(11)
    s_barrier
    ds_read_b128 v[116:119], v104 offset:32768
    ds_read_b128 v[120:123], v104 offset:33792
    s_waitcnt lgkmcnt(4)
    v_mfma_f32_32x32x16_bf16 v[64:79], v[208:211], v[124:127], v[64:79]
    v_mfma_f32_32x32x16_bf16 v[80:95], v[208:211], v[128:131], v[80:95]
    s_add_u32 s92, s89, 115712
    buffer_load_dwordx4 v[156:159], v2, s[48:51], s92 offen sc1
    ds_read_b128 v[124:127], v104 offset:34816
    ds_read_b128 v[128:131], v104 offset:35840
    s_waitcnt lgkmcnt(4)
    v_mfma_f32_32x32x16_bf16 v[64:79], v[212:215], v[108:111], v[64:79]
    v_mfma_f32_32x32x16_bf16 v[80:95], v[212:215], v[112:115], v[80:95]
    ds_read_b128 v[108:111], v104 offset:36864
    ds_read_b128 v[112:115], v104 offset:37888
    s_waitcnt lgkmcnt(4)
    v_mfma_f32_32x32x16_bf16 v[64:79], v[216:219], v[116:119], v[64:79]
    v_mfma_f32_32x32x16_bf16 v[80:95], v[216:219], v[120:123], v[80:95]
    s_add_u32 s92, s89, 116736
    buffer_load_dwordx4 v[160:163], v2, s[48:51], s92 offen sc1
    ds_read_b128 v[116:119], v104 offset:38912
    ds_read_b128 v[120:123], v104 offset:39936
    s_waitcnt lgkmcnt(4)
    v_mfma_f32_32x32x16_bf16 v[64:79], v[220:223], v[124:127], v[64:79]
    v_mfma_f32_32x32x16_bf16 v[80:95], v[220:223], v[128:131], v[80:95]
    s_add_u32 s92, s89, 117760
    buffer_load_dwordx4 v[164:167], v2, s[48:51], s92 offen sc1
    ds_read_b128 v[124:127], v104 offset:40960
    ds_read_b128 v[128:131], v104 offset:41984
    s_waitcnt lgkmcnt(4)
    v_mfma_f32_32x32x16_bf16 v[64:79], v[224:227], v[108:111], v[64:79]
    v_mfma_f32_32x32x16_bf16 v[80:95], v[224:227], v[112:115], v[80:95]
    s_add_u32 s92, s89, 118784
    buffer_load_dwordx4 v[168:171], v2, s[48:51], s92 offen sc1
    ds_read_b128 v[108:111], v104 offset:43008
    ds_read_b128 v[112:115], v104 offset:44032
    s_waitcnt lgkmcnt(4)
    v_mfma_f32_32x32x16_bf16 v[64:79], v[228:231], v[116:119], v[64:79]
    v_mfma_f32_32x32x16_bf16 v[80:95], v[228:231], v[120:123], v[80:95]
    s_add_u32 s92, s89, 119808
    buffer_load_dwordx4 v[172:175], v2, s[48:51], s92 offen sc1
    ds_read_b128 v[116:119], v104 offset:45056
    ds_read_b128 v[120:123], v104 offset:46080
    s_waitcnt lgkmcnt(4)
    v_mfma_f32_32x32x16_bf16 v[64:79], v[232:235], v[124:127], v[64:79]
    v_mfma_f32_32x32x16_bf16 v[80:95], v[232:235], v[128:131], v[80:95]
    ds_read_b128 v[124:127], v104 offset:47104
    ds_read_b128 v[128:131], v104 offset:48128
    s_waitcnt lgkmcnt(4)
    v_mfma_f32_32x32x16_bf16 v[64:79], v[236:239], v[108:111], v[64:79]
    v_mfma_f32_32x32x16_bf16 v[80:95], v[236:239], v[112:115], v[80:95]
    s_add_u32 s92, s89, 120832
    buffer_load_dwordx4 v[176:179], v2, s[48:51], s92 offen sc1
    ds_read_b128 v[108:111], v104 offset:49152
    ds_read_b128 v[112:115], v104 offset:50176
    s_waitcnt lgkmcnt(4)
    v_mfma_f32_32x32x16_bf16 v[64:79], v[240:243], v[116:119], v[64:79]
    v_mfma_f32_32x32x16_bf16 v[80:95], v[240:243], v[120:123], v[80:95]
    s_add_u32 s92, s89, 121856
    buffer_load_dwordx4 v[180:183], v2, s[48:51], s92 offen sc1
    ds_read_b128 v[116:119], v104 offset:51200
    ds_read_b128 v[120:123], v104 offset:52224
    s_waitcnt lgkmcnt(4)
    v_mfma_f32_32x32x16_bf16 v[64:79], v[244:247], v[124:127], v[64:79]
    v_mfma_f32_32x32x16_bf16 v[80:95], v[244:247], v[128:131], v[80:95]
    s_add_u32 s92, s89, 122880
    buffer_load_dwordx4 v[184:187], v2, s[48:51], s92 offen sc1
    s_cmp_eq_u32 s90, 0
    s_cbranch_scc1 L_skp_17
    s_setprio 1
L_skp_17:
    ds_read_b128 v[124:127], v104 offset:53248
    ds_read_b128 v[128:131], v104 offset:54272
    s_waitcnt lgkmcnt(4)
    v_mfma_f32_32x32x16_bf16 v[64:79], v[248:251], v[108:111], v[64:79]
    v_mfma_f32_32x32x16_bf16 v[80:95], v[248:251], v[112:115], v[80:95]
    s_add_u32 s92, s89, 123904
    buffer_load_dwordx4 v[188:191], v2, s[48:51], s92 offen sc1
    ds_read_b128 v[108:111], v104 offset:55296
    ds_read_b128 v[112:115], v104 offset:56320
    s_waitcnt lgkmcnt(4)
    v_mfma_f32_32x32x16_bf16 v[64:79], v[252:255], v[116:119], v[64:79]
    v_mfma_f32_32x32x16_bf16 v[80:95], v[252:255], v[120:123], v[80:95]
    ds_read_b128 v[116:119], v104 offset:57344
    ds_read_b128 v[120:123], v104 offset:58368
    s_waitcnt lgkmcnt(4)
    v_mfma_f32_32x32x16_bf16 v[64:79], v[40:43], v[124:127], v[64:79]
    v_mfma_f32_32x32x16_bf16 v[80:95], v[40:43], v[128:131], v[80:95]
    s_add_u32 s92, s89, 124928
    buffer_load_dwordx4 v[192:195], v2, s[48:51], s92 offen sc1
    ds_read_b128 v[124:127], v104 offset:59392
    ds_read_b128 v[128:131], v104 offset:60416
    s_waitcnt lgkmcnt(4)
    v_mfma_f32_32x32x16_bf16 v[64:79], v[44:47], v[108:111], v[64:79]
    v_mfma_f32_32x32x16_bf16 v[80:95], v[44:47], v[112:115], v[80:95]
    s_add_u32 s92, s89, 125952
    buffer_load_dwordx4 v[196:199], v2, s[48:51], s92 offen sc1
    ds_read_b128 v[108:111], v104 offset:61440
    ds_read_b128 v[112:115], v104 offset:62464
    s_waitcnt lgkmcnt(4)
    v_mfma_f32_32x32x16_bf16 v[64:79], v[48:51], v[116:119], v[64:79]
    v_mfma_f32_32x32x16_bf16 v[80:95], v[48:51], v[120:123], v[80:95]
    s_add_u32 s92, s89, 126976
    buffer_load_dwordx4 v[200:203], v2, s[48:51], s92 offen sc1
    ds_read_b128 v[116:119], v104 offset:63488
    ds_read_b128 v[120:123], v104 offset:64512
    s_waitcnt lgkmcnt(4)
    v_mfma_f32_32x32x16_bf16 v[64:79], v[52:55], v[124:127], v[64:79]
    v_mfma_f32_32x32x16_bf16 v[80:95], v[52:55], v[128:131], v[80:95]
    s_add_u32 s92, s89, 128000
    buffer_load_dwordx4 v[204:207], v2, s[48:51], s92 offen sc1
    s_waitcnt lgkmcnt(2)
    v_mfma_f32_32x32x16_bf16 v[64:79], v[96:99], v[108:111], v[64:79]
    v_mfma_f32_32x32x16_bf16 v[80:95], v[96:99], v[112:115], v[80:95]
    s_waitcnt lgkmcnt(0)
    v_mfma_f32_32x32x16_bf16 v[64:79], v[100:103], v[116:119], v[64:79]
    v_mfma_f32_32x32x16_bf16 v[80:95], v[100:103], v[120:123], v[80:95]
    v_mov_b32 v105, 150528
    v_mov_b32 v106, 1
    s_mov_b64 exec, 1
    ds_add_u32 v105, v106 offset:4
    s_mov_b64 exec, -1
    s_mov_b32 s98, 0x40000
L_spin_st:
    ds_read_b32 v106, v105 offset:0
    s_waitcnt lgkmcnt(0)
    v_readfirstlane_b32 s92, v106
    s_nop 0
    s_cmp_eq_u32 s92, 1
    s_cbranch_scc1 L_spinok_st
    s_sub_u32 s98, s98, 1
    s_cmp_eq_u32 s98, 0
    s_cbranch_scc1 L_spinok_st
    s_sleep 1
    s_branch L_spin_st
L_spinok_st:
    v_and_b32 v3, 31, v1
    v_lshlrev_b32 v3, 3, v3
    v_add_u32 v3, 147456, v3
    ds_read_b64 v[104:105], v3
    ds_read_b64 v[106:107], v3 offset:256
    v_lshrrev_b32 v3, 5, v1
    v_lshlrev_b32 v3, 4, v3
    s_lshl_b32 s92, s56, 7
    s_add_u32 s92, s92, 148480
    v_add_u32 v3, s92, v3
    ds_read_b128 v[108:111], v3 offset:0
    ds_read_b128 v[112:115], v3 offset:32
    ds_read_b128 v[116:119], v3 offset:64
    ds_read_b128 v[120:123], v3 offset:96
    ds_read_b128 v[208:211], v3 offset:1024
    ds_read_b128 v[212:215], v3 offset:1056
    ds_read_b128 v[216:219], v3 offset:1088
    ds_read_b128 v[220:223], v3 offset:1120
    s_waitcnt lgkmcnt(0)
    v_fma_f32 v64, -v104, v108, v64
    v_fma_f32 v65, -v104, v109, v65
    v_fma_f32 v66, -v104, v110, v66
    v_fma_f32 v67, -v104, v111, v67
    v_fma_f32 v68, -v104, v112, v68
    v_fma_f32 v69, -v104, v113, v69
    v_fma_f32 v70, -v104, v114, v70
    v_fma_f32 v71, -v104, v115, v71
    v_fma_f32 v72, -v104, v116, v72
    v_fma_f32 v73, -v104, v117, v73
    v_fma_f32 v74, -v104, v118, v74
    v_fma_f32 v75, -v104, v119, v75
    v_fma_f32 v76, -v104, v120, v76
    v_fma_f32 v77, -v104, v121, v77
    v_fma_f32 v78, -v104, v122, v78
    v_fma_f32 v79, -v104, v123, v79
    v_fma_f32 v64, v64, v105, v208
    v_fma_f32 v65, v65, v105, v209
    v_fma_f32 v66, v66, v105, v210
    v_fma_f32 v67, v67, v105, v211
    v_fma_f32 v68, v68, v105, v212
    v_fma_f32 v69, v69, v105, v213
    v_fma_f32 v70, v70, v105, v214
    v_fma_f32 v71, v71, v105, v215
    v_fma_f32 v72, v72, v105, v216
    v_fma_f32 v73, v73, v105, v217
    v_fma_f32 v74, v74, v105, v218
    v_fma_f32 v75, v75, v105, v219
    v_fma_f32 v76, v76, v105, v220
    v_fma_f32 v77, v77, v105, v221
    v_fma_f32 v78, v78, v105, v222
    v_fma_f32 v79, v79, v105, v223
    v_add_f32 v64, v64, |v64|
    v_add_f32 v65, v65, |v65|
    v_add_f32 v66, v66, |v66|
    v_add_f32 v67, v67, |v67|
    v_add_f32 v68, v68, |v68|
    v_add_f32 v69, v69, |v69|
    v_add_f32 v70, v70, |v70|
    v_add_f32 v71, v71, |v71|
    v_add_f32 v72, v72, |v72|
    v_add_f32 v73, v73, |v73|
    v_add_f32 v74, v74, |v74|
    v_add_f32 v75, v75, |v75|
    v_add_f32 v76, v76, |v76|
    v_add_f32 v77, v77, |v77|
    v_add_f32 v78, v78, |v78|
    v_add_f32 v79, v79, |v79|
    v_mul_f32 v64, v64, v64
    v_mul_f32 v65, v65, v65
    v_mul_f32 v66, v66, v66
    v_mul_f32 v67, v67, v67
    v_mul_f32 v68, v68, v68
    v_mul_f32 v69, v69, v69
    v_mul_f32 v70, v70, v70
    v_mul_f32 v71, v71, v71
    v_mul_f32 v72, v72, v72
    v_mul_f32 v73, v73, v73
    v_mul_f32 v74, v74, v74
    v_mul_f32 v75, v75, v75
    v_mul_f32 v76, v76, v76
    v_mul_f32 v77, v77, v77
    v_mul_f32 v78, v78, v78
    v_mul_f32 v79, v79, v79
    v_cvt_pk_bf16_f32 v236, v64, v65
    v_cvt_pk_bf16_f32 v237, v66, v67
    v_cvt_pk_bf16_f32 v238, v68, v69
    v_cvt_pk_bf16_f32 v239, v70, v71
    v_cvt_pk_bf16_f32 v240, v72, v73
    v_cvt_pk_bf16_f32 v241, v74, v75
    v_cvt_pk_bf16_f32 v242, v76, v77
    v_cvt_pk_bf16_f32 v243, v78, v79
    v_fma_f32 v80, -v106, v108, v80
    v_fma_f32 v81, -v106, v109, v81
    v_fma_f32 v82, -v106, v110, v82
    v_fma_f32 v83, -v106, v111, v83
    v_fma_f32 v84, -v106, v112, v84
    v_fma_f32 v85, -v106, v113, v85
    v_fma_f32 v86, -v106, v114, v86
    v_fma_f32 v87, -v106, v115, v87
    v_fma_f32 v88, -v106, v116, v88
    v_fma_f32 v89, -v106, v117, v89
    v_fma_f32 v90, -v106, v118, v90
    v_fma_f32 v91, -v106, v119, v91
    v_fma_f32 v92, -v106, v120, v92
    v_fma_f32 v93, -v106, v121, v93
    v_fma_f32 v94, -v106, v122, v94
    v_fma_f32 v95, -v106, v123, v95
    v_fma_f32 v80, v80, v107, v208
    v_fma_f32 v81, v81, v107, v209
    v_fma_f32 v82, v82, v107, v210
    v_fma_f32 v83, v83, v107, v211
    v_fma_f32 v84, v84, v107, v212
    v_fma_f32 v85, v85, v107, v213
    v_fma_f32 v86, v86, v107, v214
    v_fma_f32 v87, v87, v107, v215
    v_fma_f32 v88, v88, v107, v216
    v_fma_f32 v89, v89, v107, v217
    v_fma_f32 v90, v90, v107, v218
    v_fma_f32 v91, v91, v107, v219
    v_fma_f32 v92, v92, v107, v220
    v_fma_f32 v93, v93, v107, v221
    v_fma_f32 v94, v94, v107, v222
    v_fma_f32 v95, v95, v107, v223
    v_add_f32 v80, v80, |v80|
    v_add_f32 v81, v81, |v81|
    v_add_f32 v82, v82, |v82|
    v_add_f32 v83, v83, |v83|
    v_add_f32 v84, v84, |v84|
    v_add_f32 v85, v85, |v85|
    v_add_f32 v86, v86, |v86|
    v_add_f32 v87, v87, |v87|
    v_add_f32 v88, v88, |v88|
    v_add_f32 v89, v89, |v89|
    v_add_f32 v90, v90, |v90|
    v_add_f32 v91, v91, |v91|
    v_add_f32 v92, v92, |v92|
    v_add_f32 v93, v93, |v93|
    v_add_f32 v94, v94, |v94|
    v_add_f32 v95, v95, |v95|
    v_mul_f32 v80, v80, v80
    v_mul_f32 v81, v81, v81
    v_mul_f32 v82, v82, v82
    v_mul_f32 v83, v83, v83
    v_mul_f32 v84, v84, v84
    v_mul_f32 v85, v85, v85
    v_mul_f32 v86, v86, v86
    v_mul_f32 v87, v87, v87
    v_mul_f32 v88, v88, v88
    v_mul_f32 v89, v89, v89
    v_mul_f32 v90, v90, v90
    v_mul_f32 v91, v91, v91
    v_mul_f32 v92, v92, v92
    v_mul_f32 v93, v93, v93
    v_mul_f32 v94, v94, v94
    v_mul_f32 v95, v95, v95
    v_cvt_pk_bf16_f32 v244, v80, v81
    v_cvt_pk_bf16_f32 v245, v82, v83
    v_cvt_pk_bf16_f32 v246, v84, v85
    v_cvt_pk_bf16_f32 v247, v86, v87
    v_cvt_pk_bf16_f32 v248, v88, v89
    v_cvt_pk_bf16_f32 v249, v90, v91
    v_cvt_pk_bf16_f32 v250, v92, v93
    v_cvt_pk_bf16_f32 v251, v94, v95
    s_mul_i32 s92, s57, 7
    s_add_u32 s92, s92, s56
    s_lshl_b32 s93, s92, 12
    s_mul_i32 s94, s58, 229376
    s_add_u32 s93, s93, s94
    s_add_u32 s93, s93, 5242880
    s_lshl_b32 s94, s92, 2
    s_lshl_b32 s95, s58, 8
    s_add_u32 s94, s94, s95
    s_add_u32 s94, s94, 32768
    v_mov_b32 v104, s3
    v_mov_b32 v105, 0
    s_cmp_eq_u32 s61, 0
    s_cbranch_scc0 L_pub_slow_hid
    buffer_store_dwordx4 v[236:239], v2, s[48:51], s93 offen offset:0
    buffer_store_dwordx4 v[244:247], v2, s[48:51], s93 offen offset:1024
    buffer_store_dwordx4 v[240:243], v2, s[48:51], s93 offen offset:2048
    buffer_store_dwordx4 v[248:251], v2, s[48:51], s93 offen offset:3072
    s_waitcnt vmcnt(0)
    s_mov_b64 exec, 1
    buffer_store_dword v104, v105, s[48:51], s94 offen
    s_mov_b64 exec, -1
    s_branch L_pub_done_hid
L_pub_slow_hid:
    buffer_store_dwordx4 v[236:239], v2, s[48:51], s93 offen offset:0 sc1
    buffer_store_dwordx4 v[244:247], v2, s[48:51], s93 offen offset:1024 sc1
    buffer_store_dwordx4 v[240:243], v2, s[48:51], s93 offen offset:2048 sc1
    buffer_store_dwordx4 v[248:251], v2, s[48:51], s93 offen offset:3072 sc1
    s_waitcnt vmcnt(0)
    s_mov_b64 exec, 1
    buffer_store_dword v104, v105, s[48:51], s94 offen sc1
    s_mov_b64 exec, -1
L_pub_done_hid:
    s_setprio 0
    s_branch L_p4_done
L_p4_w7:
    v_lshlrev_b32 v3, 4, v1
    s_lshl_b32 s92, s58, 14
    s_add_u32 s92, s92, 393216
    buffer_load_dwordx4 v[64:67], v3, s[48:51], s92 offen offset:0 sc1
    buffer_load_dwordx4 v[68:71], v3, s[48:51], s92 offen offset:1024 sc1
    buffer_load_dwordx4 v[72:75], v3, s[48:51], s92 offen offset:2048 sc1
    buffer_load_dwordx4 v[76:79], v3, s[48:51], s92 offen offset:3072 sc1
    s_add_u32 s92, s92, 4096
    buffer_load_dwordx4 v[80:83], v3, s[48:51], s92 offen offset:0 sc1
    buffer_load_dwordx4 v[84:87], v3, s[48:51], s92 offen offset:1024 sc1
    buffer_load_dwordx4 v[88:91], v3, s[48:51], s92 offen offset:2048 sc1
    buffer_load_dwordx4 v[92:95], v3, s[48:51], s92 offen offset:3072 sc1
    s_add_u32 s92, s92, 4096
    buffer_load_dwordx4 v[96:99], v3, s[48:51], s92 offen offset:0 sc1
    buffer_load_dwordx4 v[100:103], v3, s[48:51], s92 offen offset:1024 sc1
    buffer_load_dwordx4 v[104:107], v3, s[48:51], s92 offen offset:2048 sc1
    buffer_load_dwordx4 v[108:111], v3, s[48:51], s92 offen offset:3072 sc1
    s_add_u32 s92, s92, 4096
    buffer_load_dwordx4 v[112:115], v3, s[48:51], s92 offen offset:0 sc1
    buffer_load_dwordx4 v[116:119], v3, s[48:51], s92 offen offset:1024 sc1
    buffer_load_dwordx4 v[120:123], v3, s[48:51], s92 offen offset:2048 sc1
    buffer_load_dwordx4 v[124:127], v3, s[48:51], s92 offen offset:3072 sc1
    s_waitcnt vmcnt(20)
    s_barrier
    s_waitcnt vmcnt(16)
    s_barrier
    s_add_u32 s92, s89, 4096
    buffer_load_dwordx4 v[24:27], v2, s[48:51], s92 offen sc1
    s_add_u32 s92, s89, 5120
    buffer_load_dwordx4 v[28:31], v2, s[48:51], s92 offen sc1
    s_add_u32 s92, s89, 6144
    buffer_load_dwordx4 v[32:35], v2, s[48:51], s92 offen sc1
    s_add_u32 s92, s89, 7168
    buffer_load_dwordx4 v[36:39], v2, s[48:51], s92 offen sc1
    s_add_u32 s92, s89, 8192
    buffer_load_dwordx4 v[56:59], v2, s[48:51], s92 offen sc1
    s_add_u32 s92, s89, 9216
    buffer_load_dwordx4 v[60:63], v2, s[48:51], s92 offen sc1
    s_add_u32 s92, s89, 10240
    buffer_load_dwordx4 v[132:135], v2, s[48:51], s92 offen sc1
    s_add_u32 s92, s89, 11264
    buffer_load_dwordx4 v[136:139], v2, s[48:51], s92 offen sc1
    s_add_u32 s92, s89, 12288
    buffer_load_dwordx4 v[140:143], v2, s[48:51], s92 offen sc1
    s_add_u32 s92, s89, 13312
    buffer_load_dwordx4 v[144:147], v2, s[48:51], s92 offen sc1
    s_waitcnt vmcnt(10)
    v_add_f32 v64, v64, v68
    v_add_f32 v65, v65, v69
    v_add_f32 v66, v66, v70
    v_add_f32 v67, v67, v71
    v_add_f32 v64, v64, v72
    v_add_f32 v65, v65, v73
    v_add_f32 v66, v66, v74
    v_add_f32 v67, v67, v75
    v_add_f32 v64, v64, v76
    v_add_f32 v65, v65, v77
    v_add_f32 v66, v66, v78
    v_add_f32 v67, v67, v79
    v_add_f32 v64, v64, v80
    v_add_f32 v65, v65, v81
    v_add_f32 v66, v66, v82
    v_add_f32 v67, v67, v83
    v_add_f32 v64, v64, v84
    v_add_f32 v65, v65, v85
    v_add_f32 v66, v66, v86
    v_add_f32 v67, v67, v87
    v_add_f32 v64, v64, v88
    v_add_f32 v65, v65, v89
    v_add_f32 v66, v66, v90
    v_add_f32 v67, v67, v91
    v_add_f32 v64, v64, v92
    v_add_f32 v65, v65, v93
    v_add_f32 v66, v66, v94
    v_add_f32 v67, v67, v95
    v_add_f32 v96, v96, v100
    v_add_f32 v97, v97, v101
    v_add_f32 v98, v98, v102
    v_add_f32 v99, v99, v103
    v_add_f32 v96, v96, v104
    v_add_f32 v97, v97, v105
    v_add_f32 v98, v98, v106
    v_add_f32 v99, v99, v107
    v_add_f32 v96, v96, v108
    v_add_f32 v97, v97, v109
    v_add_f32 v98, v98, v110
    v_add_f32 v99, v99, v111
    v_add_f32 v96, v96, v112
    v_add_f32 v97, v97, v113
    v_add_f32 v98, v98, v114
    v_add_f32 v99, v99, v115
    v_add_f32 v96, v96, v116
    v_add_f32 v97, v97, v117
    v_add_f32 v98, v98, v118
    v_add_f32 v99, v99, v119
    v_add_f32 v96, v96, v120
    v_add_f32 v97, v97, v121
    v_add_f32 v98, v98, v122
    v_add_f32 v99, v99, v123
    v_add_f32 v96, v96, v124
    v_add_f32 v97, v97, v125
    v_add_f32 v98, v98, v126
    v_add_f32 v99, v99, v127
    v_mov_b32 v72, v64
    v_mov_b32 v73, v65
    v_mov_b32 v74, v66
    v_mov_b32 v75, v67
    v_mov_b32 v76, v96
    v_mov_b32 v77, v97
    v_mov_b32 v78, v98
    v_mov_b32 v79, v99
    v_permlane16_swap_b32 v64, v72
    v_permlane16_swap_b32 v65, v73
    v_permlane16_swap_b32 v66, v74
    v_permlane16_swap_b32 v67, v75
    v_permlane16_swap_b32 v96, v76
    v_permlane16_swap_b32 v97, v77
    v_permlane16_swap_b32 v98, v78
    v_permlane16_swap_b32 v99, v79
    v_add_f32 v64, v64, v72
    v_add_f32 v65, v65, v73
    v_add_f32 v66, v66, v74
    v_add_f32 v67, v67, v75
    v_add_f32 v96, v96, v76
    v_add_f32 v97, v97, v77
    v_add_f32 v98, v98, v78
    v_add_f32 v99, v99, v79
    v_mov_b32 v72, v64
    v_mov_b32 v73, v65
    v_mov_b32 v74, v66
    v_mov_b32 v75, v67
    v_mov_b32 v76, v96
    v_mov_b32 v77, v97
    v_mov_b32 v78, v98
    v_mov_b32 v79, v99
    v_permlane32_swap_b32 v64, v72
    v_permlane32_swap_b32 v65, v73
    v_permlane32_swap_b32 v66, v74
    v_permlane32_swap_b32 v67, v75
    v_permlane32_swap_b32 v96, v76
    v_permlane32_swap_b32 v97, v77
    v_permlane32_swap_b32 v98, v78
    v_permlane32_swap_b32 v99, v79
    v_add_f32 v64, v64, v72
    v_add_f32 v65, v65, v73
    v_add_f32 v66, v66, v74
    v_add_f32 v67, v67, v75
    v_add_f32 v96, v96, v76
    v_add_f32 v97, v97, v77
    v_add_f32 v98, v98, v78
    v_add_f32 v99, v99, v79
    v_mul_f32 v64, 0x3b000000, v64
    v_mul_f32 v65, 0x3b000000, v65
    v_fma_f32 v65, -v64, v64, v65
    v_max_f32 v65, 0, v65
    v_add_f32 v65, 0x3727c5ac, v65
    v_rsq_f32 v65, v65
    s_nop 0
    v_mul_f32 v65, 0.5, v65
    v_mul_f32 v66, 0x3b000000, v66
    v_mul_f32 v67, 0x3b000000, v67
    v_fma_f32 v67, -v66, v66, v67
    v_max_f32 v67, 0, v67
    v_add_f32 v67, 0x3727c5ac, v67
    v_rsq_f32 v67, v67
    s_nop 0
    v_mul_f32 v67, 0.5, v67
    v_mul_f32 v96, 0x3b000000, v96
    v_mul_f32 v97, 0x3b000000, v97
    v_fma_f32 v97, -v96, v96, v97
    v_max_f32 v97, 0, v97
    v_add_f32 v97, 0x3727c5ac, v97
    v_rsq_f32 v97, v97
    s_nop 0
    v_mul_f32 v97, 0.5, v97
    v_mul_f32 v98, 0x3b000000, v98
    v_mul_f32 v99, 0x3b000000, v99
    v_fma_f32 v99, -v98, v98, v99
    v_max_f32 v99, 0, v99
    v_add_f32 v99, 0x3727c5ac, v99
    v_rsq_f32 v99, v99
    s_nop 0
    v_mul_f32 v99, 0.5, v99
    v_and_b32 v3, 15, v1
    v_lshlrev_b32 v3, 4, v3
    v_add_u32 v3, 147456, v3
    s_mov_b64 exec, 0xffff
    ds_write_b128 v3, v[64:67]
    ds_write_b128 v3, v[96:99] offset:256
    s_mov_b64 exec, -1
    s_waitcnt lgkmcnt(0)
    v_mov_b32 v104, 150528
    v_mov_b32 v105, 1
    s_mov_b64 exec, 1
    ds_write_b32 v104, v105
    s_mov_b64 exec, -1
L_p4_done:
    s_lshl_b32 s92, s57, 7
    s_lshl_b32 s93, s62, 6
    s_add_u32 s92, s92, s93
    s_lshl_b32 s93, s90, 5
    s_add_u32 s89, s92, s93
    v_lshrrev_b32 v3, 5, v1
    v_lshlrev_b32 v3, 3, v3
    buffer_load_dwordx2 v[148:149], v3, s[40:43], s89 offen
    buffer_load_dwordx2 v[150:151], v3, s[40:43], s89 offen offset:16
    v_mov_b32 v105, 150528
    s_mov_b32 s98, 0x40000
L_spin_hf:
    ds_read_b32 v106, v105 offset:4
    s_waitcnt lgkmcnt(0)
    v_readfirstlane_b32 s92, v106
    s_nop 0
    s_cmp_eq_u32 s92, 7
    s_cbranch_scc1 L_spinok_hf
    s_sub_u32 s98, s98, 1
    s_cmp_eq_u32 s98, 0
    s_cbranch_scc1 L_spinok_hf
    s_sleep 1
    s_branch L_spin_hf
L_spinok_hf:
    s_mul_i32 s92, s56, 28
    s_lshl_b32 s93, s58, 8
    s_add_u32 s92, s92, s93
    s_add_u32 s92, s92, 32768
    v_min_u32 v3, 6, v1
    v_lshlrev_b32 v3, 2, v3
    s_mov_b32 s98, 200000
L_poll_hid:
    buffer_load_dword v104, v3, s[48:51], s92 offen sc1
    s_waitcnt vmcnt(0)
    v_cmp_ne_u32 vcc, s3, v104
    s_nop 0
    s_cbranch_vccz L_pollok_hid
    s_sub_u32 s98, s98, 1
    s_cmp_eq_u32 s98, 0
    s_cbranch_scc1 L_pollok_hid
    s_sleep 1
    s_branch L_poll_hid
L_pollok_hid:
    s_mul_i32 s92, s56, 28672
    s_mul_i32 s94, s58, 229376
    s_add_u32 s92, s92, s94
    s_add_u32 s67, s92, 5242880
    s_add_u32 s92, s67, 0
    buffer_load_dwordx4 v[40:43], v2, s[48:51], s92 offen sc1
    s_add_u32 s92, s67, 2048
    buffer_load_dwordx4 v[44:47], v2, s[48:51], s92 offen sc1
    s_add_u32 s92, s67, 4096
    buffer_load_dwordx4 v[48:51], v2, s[48:51], s92 offen sc1
    s_add_u32 s92, s67, 6144
    buffer_load_dwordx4 v[52:55], v2, s[48:51], s92 offen sc1
    s_add_u32 s92, s67, 8192
    buffer_load_dwordx4 v[96:99], v2, s[48:51], s92 offen sc1
    s_add_u32 s92, s67, 10240
    buffer_load_dwordx4 v[100:103], v2, s[48:51], s92 offen sc1
    s_add_u32 s92, s67, 12288
    buffer_load_dwordx4 v[108:111], v2, s[48:51], s92 offen sc1
    s_add_u32 s92, s67, 14336
    buffer_load_dwordx4 v[112:115], v2, s[48:51], s92 offen sc1
    s_add_u32 s92, s67, 16384
    buffer_load_dwordx4 v[116:119], v2, s[48:51], s92 offen sc1
    s_add_u32 s92, s67, 18432
    buffer_load_dwordx4 v[120:123], v2, s[48:51], s92 offen sc1
    s_add_u32 s92, s67, 20480
    buffer_load_dwordx4 v[124:127], v2, s[48:51], s92 offen sc1
    s_add_u32 s92, s67, 22528
    buffer_load_dwordx4 v[128:131], v2, s[48:51], s92 offen sc1
    s_add_u32 s92, s67, 24576
    buffer_load_dwordx4 v[240:243], v2, s[48:51], s92 offen sc1
    s_add_u32 s92, s67, 26624
    buffer_load_dwordx4 v[244:247], v2, s[48:51], s92 offen sc1
    s_lshl_b32 s92, s56, 11
    v_add_u32 v104, s92, v2
    v_add_u32 v105, 65536, v104
    s_waitcnt vmcnt(13)
    v_mfma_f32_32x32x16_bf16 v[64:79], v[8:11], v[40:43], 0
    v_mfma_f32_32x32x16_bf16 v[208:223], v[152:155], v[40:43], 0
    s_add_u32 s92, s67, 1024
    buffer_load_dwordx4 v[40:43], v2, s[48:51], s92 offen sc1
    s_waitcnt vmcnt(13)
    v_mfma_f32_32x32x16_bf16 v[64:79], v[12:15], v[44:47], v[64:79]
    v_mfma_f32_32x32x16_bf16 v[208:223], v[156:159], v[44:47], v[208:223]
    s_add_u32 s92, s67, 3072
    buffer_load_dwordx4 v[44:47], v2, s[48:51], s92 offen sc1
    s_waitcnt vmcnt(13)
    v_mfma_f32_32x32x16_bf16 v[64:79], v[16:19], v[48:51], v[64:79]
    v_mfma_f32_32x32x16_bf16 v[208:223], v[160:163], v[48:51], v[208:223]
    s_add_u32 s92, s67, 5120
    buffer_load_dwordx4 v[48:51], v2, s[48:51], s92 offen sc1
    s_waitcnt vmcnt(13)
    v_mfma_f32_32x32x16_bf16 v[64:79], v[20:23], v[52:55], v[64:79]
    v_mfma_f32_32x32x16_bf16 v[208:223], v[164:167], v[52:55], v[208:223]
    s_add_u32 s92, s67, 7168
    buffer_load_dwordx4 v[52:55], v2, s[48:51], s92 offen sc1
    s_waitcnt vmcnt(13)
    v_mfma_f32_32x32x16_bf16 v[64:79], v[24:27], v[96:99], v[64:79]
    v_mfma_f32_32x32x16_bf16 v[208:223], v[168:171], v[96:99], v[208:223]
    s_add_u32 s92, s67, 9216
    buffer_load_dwordx4 v[96:99], v2, s[48:51], s92 offen sc1
    s_waitcnt vmcnt(13)
    v_mfma_f32_32x32x16_bf16 v[64:79], v[28:31], v[100:103], v[64:79]
    v_mfma_f32_32x32x16_bf16 v[208:223], v[172:175], v[100:103], v[208:223]
    s_add_u32 s92, s67, 11264
    buffer_load_dwordx4 v[100:103], v2, s[48:51], s92 offen sc1
    s_waitcnt vmcnt(13)
    v_mfma_f32_32x32x16_bf16 v[64:79], v[32:35], v[108:111], v[64:79]
    v_mfma_f32_32x32x16_bf16 v[208:223], v[176:179], v[108:111], v[208:223]
    s_add_u32 s92, s67, 13312
    buffer_load_dwordx4 v[108:111], v2, s[48:51], s92 offen sc1
    s_waitcnt vmcnt(13)
    v_mfma_f32_32x32x16_bf16 v[64:79], v[36:39], v[112:115], v[64:79]
    v_mfma_f32_32x32x16_bf16 v[208:223], v[180:183], v[112:115], v[208:223]
    s_add_u32 s92, s67, 15360
    buffer_load_dwordx4 v[112:115], v2, s[48:51], s92 offen sc1
    s_waitcnt vmcnt(13)
    v_mfma_f32_32x32x16_bf16 v[64:79], v[56:59], v[116:119], v[64:79]
    v_mfma_f32_32x32x16_bf16 v[208:223], v[184:187], v[116:119], v[208:223]
    s_add_u32 s92, s67, 17408
    buffer_load_dwordx4 v[116:119], v2, s[48:51], s92 offen sc1
    s_waitcnt vmcnt(13)
    v_mfma_f32_32x32x16_bf16 v[64:79], v[60:63], v[120:123], v[64:79]
    v_mfma_f32_32x32x16_bf16 v[208:223], v[188:191], v[120:123], v[208:223]
    s_add_u32 s92, s67, 19456
    buffer_load_dwordx4 v[120:123], v2, s[48:51], s92 offen sc1
    s_waitcnt vmcnt(13)
    v_mfma_f32_32x32x16_bf16 v[64:79], v[132:135], v[124:127], v[64:79]
    v_mfma_f32_32x32x16_bf16 v[208:223], v[192:195], v[124:127], v[208:223]
    s_add_u32 s92, s67, 21504
    buffer_load_dwordx4 v[124:127], v2, s[48:51], s92 offen sc1
    s_waitcnt vmcnt(13)
    v_mfma_f32_32x32x16_bf16 v[64:79], v[136:139], v[128:131], v[64:79]
    v_mfma_f32_32x32x16_bf16 v[208:223], v[196:199], v[128:131], v[208:223]
    s_add_u32 s92, s67, 23552
    buffer_load_dwordx4 v[128:131], v2, s[48:51], s92 offen sc1
    s_waitcnt vmcnt(13)
    v_mfma_f32_32x32x16_bf16 v[64:79], v[140:143], v[240:243], v[64:79]
    v_mfma_f32_32x32x16_bf16 v[208:223], v[200:203], v[240:243], v[208:223]
    s_add_u32 s92, s67, 25600
    buffer_load_dwordx4 v[240:243], v2, s[48:51], s92 offen sc1
    s_waitcnt vmcnt(13)
    v_mfma_f32_32x32x16_bf16 v[64:79], v[144:147], v[244:247], v[64:79]
    v_mfma_f32_32x32x16_bf16 v[208:223], v[204:207], v[244:247], v[208:223]
    s_add_u32 s92, s67, 27648
    buffer_load_dwordx4 v[244:247], v2, s[48:51], s92 offen sc1
    s_waitcnt vmcnt(13)
    v_mfma_f32_32x32x16_bf16 v[80:95], v[8:11], v[40:43], 0
    v_mfma_f32_32x32x16_bf16 v[224:239], v[152:155], v[40:43], 0
    s_waitcnt vmcnt(12)
    v_mfma_f32_32x32x16_bf16 v[80:95], v[12:15], v[44:47], v[80:95]
    v_mfma_f32_32x32x16_bf16 v[224:239], v[156:159], v[44:47], v[224:239]
    s_waitcnt vmcnt(11)
    v_mfma_f32_32x32x16_bf16 v[80:95], v[16:19], v[48:51], v[80:95]
    v_mfma_f32_32x32x16_bf16 v[224:239], v[160:163], v[48:51], v[224:239]
    ds_write_b128 v104, v[64:67] offset:0
    ds_write_b128 v104, v[68:71] offset:1024
    s_waitcnt vmcnt(10)
    v_mfma_f32_32x32x16_bf16 v[80:95], v[20:23], v[52:55], v[80:95]
    v_mfma_f32_32x32x16_bf16 v[224:239], v[164:167], v[52:55], v[224:239]
    s_waitcnt vmcnt(9)
    v_mfma_f32_32x32x16_bf16 v[80:95], v[24:27], v[96:99], v[80:95]
    v_mfma_f32_32x32x16_bf16 v[224:239], v[168:171], v[96:99], v[224:239]
    ds_write_b128 v105, v[72:75] offset:0
    ds_write_b128 v105, v[76:79] offset:1024
    s_waitcnt vmcnt(8)
    v_mfma_f32_32x32x16_bf16 v[80:95], v[28:31], v[100:103], v[80:95]
    v_mfma_f32_32x32x16_bf16 v[224:239], v[172:175], v[100:103], v[224:239]
    s_waitcnt vmcnt(7)
    v_mfma_f32_32x32x16_bf16 v[80:95], v[32:35], v[108:111], v[80:95]
    v_mfma_f32_32x32x16_bf16 v[224:239], v[176:179], v[108:111], v[224:239]
    ds_write_b128 v104, v[208:211] offset:32768
    ds_write_b128 v104, v[212:215] offset:33792
    s_waitcnt vmcnt(6)
    v_mfma_f32_32x32x16_bf16 v[80:95], v[36:39], v[112:115], v[80:95]
    v_mfma_f32_32x32x16_bf16 v[224:239], v[180:183], v[112:115], v[224:239]
    s_waitcnt vmcnt(5)
    v_mfma_f32_32x32x16_bf16 v[80:95], v[56:59], v[116:119], v[80:95]
    v_mfma_f32_32x32x16_bf16 v[224:239], v[184:187], v[116:119], v[224:239]
    ds_write_b128 v105, v[216:219] offset:32768
    ds_write_b128 v105, v[220:223] offset:33792
    s_waitcnt vmcnt(4)
    v_mfma_f32_32x32x16_bf16 v[80:95], v[60:63], v[120:123], v[80:95]
    v_mfma_f32_32x32x16_bf16 v[224:239], v[188:191], v[120:123], v[224:239]
    s_waitcnt vmcnt(3)
    v_mfma_f32_32x32x16_bf16 v[80:95], v[132:135], v[124:127], v[80:95]
    v_mfma_f32_32x32x16_bf16 v[224:239], v[192:195], v[124:127], v[224:239]
    s_waitcnt vmcnt(2)
    v_mfma_f32_32x32x16_bf16 v[80:95], v[136:139], v[128:131], v[80:95]
    v_mfma_f32_32x32x16_bf16 v[224:239], v[196:199], v[128:131], v[224:239]
    s_waitcnt vmcnt(1)
    v_mfma_f32_32x32x16_bf16 v[80:95], v[140:143], v[240:243], v[80:95]
    v_mfma_f32_32x32x16_bf16 v[224:239], v[200:203], v[240:243], v[224:239]
    s_waitcnt vmcnt(0)
    v_mfma_f32_32x32x16_bf16 v[80:95], v[144:147], v[244:247], v[80:95]
    v_mfma_f32_32x32x16_bf16 v[224:239], v[204:207], v[244:247], v[224:239]
    s_nop 10
    ds_write_b128 v104, v[80:83] offset:16384
    ds_write_b128 v104, v[84:87] offset:17408
    ds_write_b128 v105, v[88:91] offset:16384
    ds_write_b128 v105, v[92:95] offset:17408
    ds_write_b128 v104, v[224:227] offset:49152
    ds_write_b128 v104, v[228:231] offset:50176
    ds_write_b128 v105, v[232:235] offset:49152
    ds_write_b128 v105, v[236:239] offset:50176
    v_lshlrev_b32 v16, 16, v4
    v_and_b32 v17, 0xffff0000, v4
    v_lshlrev_b32 v24, 16, v148
    v_and_b32 v25, 0xffff0000, v148
    v_lshlrev_b32 v18, 16, v5
    v_and_b32 v19, 0xffff0000, v5
    v_lshlrev_b32 v26, 16, v149
    v_and_b32 v27, 0xffff0000, v149
    v_lshlrev_b32 v20, 16, v6
    v_and_b32 v21, 0xffff0000, v6
    v_lshlrev_b32 v28, 16, v150
    v_and_b32 v29, 0xffff0000, v150
    v_lshlrev_b32 v22, 16, v7
    v_and_b32 v23, 0xffff0000, v7
    v_lshlrev_b32 v30, 16, v151
    v_and_b32 v31, 0xffff0000, v151
    v_add_f32 v16, v16, v24
    v_add_f32 v17, v17, v25
    v_add_f32 v18, v18, v26
    v_add_f32 v19, v19, v27
    v_add_f32 v20, v20, v28
    v_add_f32 v21, v21, v29
    v_add_f32 v22, v22, v30
    v_add_f32 v23, v23, v31
    v_and_b32 v3, 31, v1
    v_lshlrev_b32 v3, 10, v3
    v_lshrrev_b32 v12, 5, v1
    v_lshl_or_b32 v3, v12, 4, v3
    s_lshl_b32 s93, s56, 14
    v_add_u32 v106, s93, v2
    s_lshl_b32 s92, s63, 5
    s_add_u32 s92, s92, s59
    s_lshl_b32 s92, s92, 10
    s_add_u32 s92, s92, s89
    s_waitcnt lgkmcnt(0)
    s_barrier
    ds_read_b128 v[152:155], v106 offset:0
    ds_read_b128 v[156:159], v106 offset:1024
    ds_read_b128 v[160:163], v106 offset:2048
    ds_read_b128 v[164:167], v106 offset:3072
    ds_read_b128 v[168:171], v106 offset:4096
    ds_read_b128 v[172:175], v106 offset:5120
    ds_read_b128 v[176:179], v106 offset:6144
    ds_read_b128 v[180:183], v106 offset:7168
    ds_read_b128 v[184:187], v106 offset:8192
    ds_read_b128 v[188:191], v106 offset:9216
    ds_read_b128 v[192:195], v106 offset:10240
    ds_read_b128 v[196:199], v106 offset:11264
    ds_read_b128 v[200:203], v106 offset:12288
    ds_read_b128 v[204:207], v106 offset:13312
    ds_read_b128 v[208:211], v106 offset:14336
    ds_read_b128 v[212:215], v106 offset:15360
    s_waitcnt lgkmcnt(14)
    v_add_f32 v16, v16, v152
    v_add_f32 v17, v17, v153
    v_add_f32 v18, v18, v154
    v_add_f32 v19, v19, v155
    v_add_f32 v20, v20, v156
    v_add_f32 v21, v21, v157
    v_add_f32 v22, v22, v158
    v_add_f32 v23, v23, v159
    s_waitcnt lgkmcnt(12)
    v_add_f32 v16, v16, v160
    v_add_f32 v17, v17, v161
    v_add_f32 v18, v18, v162
    v_add_f32 v19, v19, v163
    v_add_f32 v20, v20, v164
    v_add_f32 v21, v21, v165
    v_add_f32 v22, v22, v166
    v_add_f32 v23, v23, v167
    s_waitcnt lgkmcnt(10)
    v_add_f32 v16, v16, v168
    v_add_f32 v17, v17, v169
    v_add_f32 v18, v18, v170
    v_add_f32 v19, v19, v171
    v_add_f32 v20, v20, v172
    v_add_f32 v21, v21, v173
    v_add_f32 v22, v22, v174
    v_add_f32 v23, v23, v175
    s_waitcnt lgkmcnt(8)
    v_add_f32 v16, v16, v176
    v_add_f32 v17, v17, v177
    v_add_f32 v18, v18, v178
    v_add_f32 v19, v19, v179
    v_add_f32 v20, v20, v180
    v_add_f32 v21, v21, v181
    v_add_f32 v22, v22, v182
    v_add_f32 v23, v23, v183
    s_waitcnt lgkmcnt(6)
    v_add_f32 v16, v16, v184
    v_add_f32 v17, v17, v185
    v_add_f32 v18, v18, v186
    v_add_f32 v19, v19, v187
    v_add_f32 v20, v20, v188
    v_add_f32 v21, v21, v189
    v_add_f32 v22, v22, v190
    v_add_f32 v23, v23, v191
    s_waitcnt lgkmcnt(4)
    v_add_f32 v16, v16, v192
    v_add_f32 v17, v17, v193
    v_add_f32 v18, v18, v194
    v_add_f32 v19, v19, v195
    v_add_f32 v20, v20, v196
    v_add_f32 v21, v21, v197
    v_add_f32 v22, v22, v198
    v_add_f32 v23, v23, v199
    s_waitcnt lgkmcnt(2)
    v_add_f32 v16, v16, v200
    v_add_f32 v17, v17, v201
    v_add_f32 v18, v18, v202
    v_add_f32 v19, v19, v203
    v_add_f32 v20, v20, v204
    v_add_f32 v21, v21, v205
    v_add_f32 v22, v22, v206
    v_add_f32 v23, v23, v207
    s_waitcnt lgkmcnt(0)
    v_add_f32 v16, v16, v208
    v_add_f32 v17, v17, v209
    v_add_f32 v18, v18, v210
    v_add_f32 v19, v19, v211
    v_add_f32 v20, v20, v212
    v_add_f32 v21, v21, v213
    v_add_f32 v22, v22, v214
    v_add_f32 v23, v23, v215
    v_cvt_pk_bf16_f32 v88, v16, v17
    v_cvt_pk_bf16_f32 v89, v18, v19
    v_cvt_pk_bf16_f32 v90, v20, v21
    v_cvt_pk_bf16_f32 v91, v22, v23
    s_nop 0
    v_permlane32_swap_b32 v88, v90
    v_permlane32_swap_b32 v89, v91
    buffer_store_dwordx4 v[88:91], v3, s[44:47], s92 offen
    s_waitcnt vmcnt(0)
L_end:
    s_endpgm
.section .rodata,"a"
.p2align 6
.amdhsa_kernel sequential_preLN__grouped_kv_mqa__dense_activation_squared_relu__prompt_kernel
  .amdhsa_next_free_vgpr 256
  .amdhsa_next_free_sgpr 102
  .amdhsa_accum_offset 256
  .amdhsa_group_segment_fixed_size 0
  .amdhsa_kernarg_size 104
  .amdhsa_user_sgpr_count 2
  .amdhsa_user_sgpr_kernarg_segment_ptr 1
  .amdhsa_system_sgpr_workgroup_id_x 1
.end_amdhsa_kernel
```
